```python
import torch

def _softmax(x, axis=-1):
    return torch.softmax(x, dim=axis)
def _gelu(x):
    return torch.nn.functional.gelu(x, approximate="tanh")
def _silu(x):
    return torch.nn.functional.silu(x)
def _sigmoid(x):
    return torch.sigmoid(x)
def _layernorm(x, axis=-1, eps=1e-5):
    m = x.mean(dim=axis, keepdim=True)
    v = x.var(dim=axis, keepdim=True, unbiased=False)
    return (x - m) / torch.sqrt(v + eps)
def _scatter_add(tgt, idx, src, axis=0):
    return tgt.clone().index_add_(axis, idx, src)
def _segment_sum(src, seg, n):
    out = torch.zeros((n,) + src.shape[1:], dtype=src.dtype)
    return out.index_add_(0, seg, src)
def _pad(x, pw):
    flat = tuple(v for pair in reversed(pw) for v in pair)
    return torch.nn.functional.pad(x, flat)

kernel_name = 'standalone__gqa_block_cached__near_ridge'

def setup_inputs():

    _w = (lambda a: (lambda t: t.to(torch.bfloat16) if t.is_floating_point() else t)(torch.as_tensor(a)))
    B, Sq, D = 8, 96, 640
    Hq, Hkv, Sk, Dh = 32, 32, 512, 128
    assert Hq % Hkv == 0, (Hq, Hkv)
    return {
        "x": _w((lambda *s: torch.randn(*s, dtype=torch.bfloat16) * 0.8)(B, Sq, D)),
        "k_cache": _w((lambda *s: torch.randn(*s, dtype=torch.bfloat16) * 0.8)(B, Hkv, Sk, Dh)),
        "v_cache": _w((lambda *s: torch.randn(*s, dtype=torch.bfloat16) * 0.05)(B, Hkv, Sk, Dh)),
        "wq": _w((lambda *s: torch.randn(*s, dtype=torch.bfloat16) * 0.8)(D, Hq * Dh) * (D ** -0.5)),
        "wo": _w((lambda *s: torch.randn(*s, dtype=torch.bfloat16) * 0.05)(Hq * Dh, D) * ((Hq * Dh) ** -0.5)),
    }

def reference(x, k_cache, v_cache, wq, wo):
    B, Sq, D = x.shape
    Hq, Dh = 32, 128
    Hkv = k_cache.shape[1]
    rep = Hq // Hkv
    q = (lambda x, *d: x.permute(*d))((x @ wq).reshape(B, Sq, Hq, Dh), 0, 2, 1, 3)
    k = (lambda x, n, axis: torch.repeat_interleave(x, n, dim=axis))(k_cache, rep, axis=1)
    v = (lambda x, n, axis: torch.repeat_interleave(x, n, dim=axis))(v_cache, rep, axis=1)
    scores = torch.einsum("bhqd,bhkd->bhqk", q, k) * (Dh ** -0.5)
    p = _softmax(scores, axis=-1)
    o = torch.einsum("bhqk,bhkd->bhqd", p, v)
    return (lambda x, *d: x.permute(*d))(o, 0, 2, 1, 3).reshape(B, Sq, Hq * Dh) @ wo
```

```asm
; @launch grid=(256,1,1) block=(256,1,1) lds=163840
.amdgcn_target "amdgcn-amd-amdhsa--gfx950"
.text
.globl standalone__gqa_block_cached__near_ridge_kernel
.p2align 8
.type standalone__gqa_block_cached__near_ridge_kernel,@function
standalone__gqa_block_cached__near_ridge_kernel:
    s_cmp_ge_u32 s2, 256
    s_cbranch_scc1 A_end
    s_load_dwordx4 s[4:7], s[0:1], 0
    s_load_dwordx4 s[8:11], s[0:1], 16
    s_load_dwordx2 s[12:13], s[0:1], 56
    s_load_dwordx2 s[52:53], s[0:1], 32
    s_load_dwordx4 s[96:99], s[0:1], 48
    s_load_dwordx2 s[100:101], s[0:1], 40
    s_and_b32 s14, s2, 7
    s_lshl_b32 s14, s14, 2
    s_bfe_u32 s15, s2, 0x20003
    s_add_u32 s14, s14, s15
    s_lshr_b32 s15, s2, 5
    v_lshrrev_b32 v1, 6, v0
    v_and_b32 v0, 63, v0
    s_nop 0
    v_readfirstlane_b32 s16, v1
    s_lshl_b32 s17, s15, 5
    s_add_u32 s17, s17, s14
    s_mul_i32 s41, s17, 24576
    s_lshl_b32 s17, s17, 17
    s_mul_i32 s18, s15, 122880
    s_lshl_b32 s19, s14, 8
    s_and_b32 s42, s2, 7
    s_mul_i32 s42, s42, 655360
    s_and_b32 s43, s14, 3
    s_mul_i32 s43, s43, 320
    s_add_u32 s42, s42, s43
    s_waitcnt lgkmcnt(0)
    s_add_u32 s52, s52, s42
    s_addc_u32 s53, s53, 0
    s_sub_u32 s42, 5242880, s42
    s_mov_b32 s48, s52
    s_and_b32 s49, s53, 0xffff
    s_mov_b32 s50, s42
    s_mov_b32 s51, 0x00020000
    s_add_u32 s4, s4, s18
    s_addc_u32 s5, s5, 0
    s_mov_b32 s20, s4
    s_and_b32 s21, s5, 0xffff
    s_mov_b32 s22, 0x1e000
    s_mov_b32 s23, 0x00020000
    s_add_u32 s6, s6, s17
    s_addc_u32 s7, s7, 0
    s_mov_b32 s24, s6
    s_and_b32 s25, s7, 0xffff
    s_mov_b32 s26, 0x20000
    s_mov_b32 s27, 0x00020000
    s_add_u32 s8, s8, s17
    s_addc_u32 s9, s9, 0
    s_mov_b32 s28, s8
    s_and_b32 s29, s9, 0xffff
    s_mov_b32 s30, 0x20000
    s_mov_b32 s31, 0x00020000
    s_add_u32 s10, s10, s19
    s_addc_u32 s11, s11, 0
    s_sub_u32 s42, 5242880, s19
    s_mov_b32 s32, s10
    s_and_b32 s33, s11, 0xffff
    s_mov_b32 s34, s42
    s_mov_b32 s35, 0x00020000
    s_add_u32 s12, s12, s41
    s_addc_u32 s13, s13, 0
    s_mov_b32 s36, s12
    s_and_b32 s37, s13, 0xffff
    s_mov_b32 s38, 0x6000
    s_mov_b32 s39, 0x00020000
    s_cmp_eq_u32 s16, 3
    s_cbranch_scc1 A_loader
    v_and_b32 v18, 31, v0
    v_lshrrev_b32 v19, 5, v0
    v_lshrrev_b32 v20, 4, v0
    v_and_b32 v21, 15, v0
    s_lshl_b32 s40, s16, 5
    v_add_u32 v22, s40, v18
    v_lshlrev_b32 v13, 13, v22
    v_lshl_add_u32 v13, v19, 4, v13
    v_lshlrev_b32 v249, 2, v20
    v_xor_b32 v249, v21, v249
    v_lshlrev_b32 v249, 4, v249
    v_lshl_add_u32 v248, v20, 13, v249
    s_and_b32 s43, s14, 3
    s_add_u32 s43, s43, s15
    s_cmp_ge_u32 s43, 5
    s_cselect_b32 s40, 5, 0
    s_sub_u32 s43, s43, s40
    s_cmp_ge_u32 s43, 5
    s_cselect_b32 s40, 5, 0
    s_sub_u32 s43, s43, s40
    s_lshl_b32 s45, s43, 2
    s_lshl_b32 s40, s16, 5
    v_add_u32 v249, 0, v20
    v_xor_b32 v254, v249, v21
    v_add_u32 v249, s40, v249
    v_mul_u32_u24 v249, 1280, v249
    v_lshl_add_u32 v250, v254, 4, v249
    v_add_u32 v249, 4, v20
    v_xor_b32 v254, v249, v21
    v_add_u32 v249, s40, v249
    v_mul_u32_u24 v249, 1280, v249
    v_lshl_add_u32 v251, v254, 4, v249
    v_add_u32 v249, 8, v20
    v_xor_b32 v254, v249, v21
    v_add_u32 v249, s40, v249
    v_mul_u32_u24 v249, 1280, v249
    v_lshl_add_u32 v252, v254, 4, v249
    v_add_u32 v249, 12, v20
    v_xor_b32 v254, v249, v21
    v_add_u32 v249, s40, v249
    v_mul_u32_u24 v249, 1280, v249
    v_lshl_add_u32 v253, v254, 4, v249
    s_add_u32 s47, s16, 1
    s_mul_i32 s47, s47, 40960
    s_mov_b32 m0, s47
    s_lshl_b32 s40, s43, 8
    buffer_load_dwordx4 v250, s[20:23], s40 offen lds
    s_add_u32 m0, m0, 1024
    s_nop 0
    buffer_load_dwordx4 v251, s[20:23], s40 offen lds
    s_add_u32 m0, m0, 1024
    s_nop 0
    buffer_load_dwordx4 v252, s[20:23], s40 offen lds
    s_add_u32 m0, m0, 1024
    s_nop 0
    buffer_load_dwordx4 v253, s[20:23], s40 offen lds
    s_add_u32 m0, m0, 1024
    s_add_u32 s41, s40, 20480
    buffer_load_dwordx4 v250, s[20:23], s41 offen lds
    s_add_u32 m0, m0, 1024
    s_nop 0
    buffer_load_dwordx4 v251, s[20:23], s41 offen lds
    s_add_u32 m0, m0, 1024
    s_nop 0
    buffer_load_dwordx4 v252, s[20:23], s41 offen lds
    s_add_u32 m0, m0, 1024
    s_nop 0
    buffer_load_dwordx4 v253, s[20:23], s41 offen lds
    s_add_u32 m0, m0, 1024
    s_add_u32 s40, s40, 256
    s_cmp_ge_u32 s40, 1280
    s_cselect_b32 s41, 1280, 0
    s_sub_u32 s40, s40, s41
    buffer_load_dwordx4 v250, s[20:23], s40 offen lds
    s_add_u32 m0, m0, 1024
    s_nop 0
    buffer_load_dwordx4 v251, s[20:23], s40 offen lds
    s_add_u32 m0, m0, 1024
    s_nop 0
    buffer_load_dwordx4 v252, s[20:23], s40 offen lds
    s_add_u32 m0, m0, 1024
    s_nop 0
    buffer_load_dwordx4 v253, s[20:23], s40 offen lds
    s_add_u32 m0, m0, 1024
    s_add_u32 s41, s40, 20480
    buffer_load_dwordx4 v250, s[20:23], s41 offen lds
    s_add_u32 m0, m0, 1024
    s_nop 0
    buffer_load_dwordx4 v251, s[20:23], s41 offen lds
    s_add_u32 m0, m0, 1024
    s_nop 0
    buffer_load_dwordx4 v252, s[20:23], s41 offen lds
    s_add_u32 m0, m0, 1024
    s_nop 0
    buffer_load_dwordx4 v253, s[20:23], s41 offen lds
    s_add_u32 m0, m0, 1024
    s_add_u32 s40, s40, 256
    s_cmp_ge_u32 s40, 1280
    s_cselect_b32 s41, 1280, 0
    s_sub_u32 s40, s40, s41
    buffer_load_dwordx4 v250, s[20:23], s40 offen lds
    s_add_u32 m0, m0, 1024
    s_nop 0
    buffer_load_dwordx4 v251, s[20:23], s40 offen lds
    s_add_u32 m0, m0, 1024
    s_nop 0
    buffer_load_dwordx4 v252, s[20:23], s40 offen lds
    s_add_u32 m0, m0, 1024
    s_nop 0
    buffer_load_dwordx4 v253, s[20:23], s40 offen lds
    s_add_u32 m0, m0, 1024
    s_add_u32 s41, s40, 20480
    buffer_load_dwordx4 v250, s[20:23], s41 offen lds
    s_add_u32 m0, m0, 1024
    s_nop 0
    buffer_load_dwordx4 v251, s[20:23], s41 offen lds
    s_add_u32 m0, m0, 1024
    s_nop 0
    buffer_load_dwordx4 v252, s[20:23], s41 offen lds
    s_add_u32 m0, m0, 1024
    s_nop 0
    buffer_load_dwordx4 v253, s[20:23], s41 offen lds
    s_add_u32 m0, m0, 1024
    s_add_u32 s40, s40, 256
    s_cmp_ge_u32 s40, 1280
    s_cselect_b32 s41, 1280, 0
    s_sub_u32 s40, s40, s41
    buffer_load_dwordx4 v250, s[20:23], s40 offen lds
    s_add_u32 m0, m0, 1024
    s_nop 0
    buffer_load_dwordx4 v251, s[20:23], s40 offen lds
    s_add_u32 m0, m0, 1024
    s_nop 0
    buffer_load_dwordx4 v252, s[20:23], s40 offen lds
    s_add_u32 m0, m0, 1024
    s_nop 0
    buffer_load_dwordx4 v253, s[20:23], s40 offen lds
    s_add_u32 m0, m0, 1024
    s_add_u32 s41, s40, 20480
    buffer_load_dwordx4 v250, s[20:23], s41 offen lds
    s_add_u32 m0, m0, 1024
    s_nop 0
    buffer_load_dwordx4 v251, s[20:23], s41 offen lds
    s_add_u32 m0, m0, 1024
    s_nop 0
    buffer_load_dwordx4 v252, s[20:23], s41 offen lds
    s_add_u32 m0, m0, 1024
    s_nop 0
    buffer_load_dwordx4 v253, s[20:23], s41 offen lds
    s_add_u32 m0, m0, 1024
    s_add_u32 s40, s40, 256
    s_cmp_ge_u32 s40, 1280
    s_cselect_b32 s41, 1280, 0
    s_sub_u32 s40, s40, s41
    buffer_load_dwordx4 v250, s[20:23], s40 offen lds
    s_add_u32 m0, m0, 1024
    s_nop 0
    buffer_load_dwordx4 v251, s[20:23], s40 offen lds
    s_add_u32 m0, m0, 1024
    s_nop 0
    buffer_load_dwordx4 v252, s[20:23], s40 offen lds
    s_add_u32 m0, m0, 1024
    s_nop 0
    buffer_load_dwordx4 v253, s[20:23], s40 offen lds
    s_add_u32 m0, m0, 1024
    s_add_u32 s41, s40, 20480
    buffer_load_dwordx4 v250, s[20:23], s41 offen lds
    s_add_u32 m0, m0, 1024
    s_nop 0
    buffer_load_dwordx4 v251, s[20:23], s41 offen lds
    s_add_u32 m0, m0, 1024
    s_nop 0
    buffer_load_dwordx4 v252, s[20:23], s41 offen lds
    s_add_u32 m0, m0, 1024
    s_nop 0
    buffer_load_dwordx4 v253, s[20:23], s41 offen lds
    s_mov_b32 s46, s16
    s_lshl_b32 m0, s46, 13
    s_add_u32 s40, s46, s45
    s_cmp_ge_u32 s40, 20
    s_cselect_b32 s41, 20, 0
    s_sub_u32 s40, s40, s41
    s_lshl_b32 s40, s40, 18
    s_add_u32 s46, s46, 1
    buffer_load_dwordx4 v248, s[32:35], s40 offen lds
    s_add_u32 m0, m0, 1024
    s_add_u32 s40, s40, 32768
    buffer_load_dwordx4 v248, s[32:35], s40 offen lds
    s_add_u32 m0, m0, 1024
    s_add_u32 s40, s40, 32768
    buffer_load_dwordx4 v248, s[32:35], s40 offen lds
    s_add_u32 m0, m0, 1024
    s_add_u32 s40, s40, 32768
    buffer_load_dwordx4 v248, s[32:35], s40 offen lds
    s_add_u32 m0, m0, 1024
    s_add_u32 s40, s40, 32768
    buffer_load_dwordx4 v248, s[32:35], s40 offen lds
    s_add_u32 m0, m0, 1024
    s_add_u32 s40, s40, 32768
    buffer_load_dwordx4 v248, s[32:35], s40 offen lds
    s_add_u32 m0, m0, 1024
    s_add_u32 s40, s40, 32768
    buffer_load_dwordx4 v248, s[32:35], s40 offen lds
    s_add_u32 m0, m0, 1024
    s_add_u32 s40, s40, 32768
    buffer_load_dwordx4 v248, s[32:35], s40 offen lds
    s_add_u32 s46, s16, 3
    s_cmp_eq_u32 s16, 2
    s_cselect_b32 s46, 2, s46
    s_lshl_b32 m0, s46, 13
    s_add_u32 s40, s46, s45
    s_cmp_ge_u32 s40, 20
    s_cselect_b32 s41, 20, 0
    s_sub_u32 s40, s40, s41
    s_lshl_b32 s40, s40, 18
    s_add_u32 s46, s46, 1
    buffer_load_dwordx4 v248, s[32:35], s40 offen lds
    s_add_u32 m0, m0, 1024
    s_add_u32 s40, s40, 32768
    buffer_load_dwordx4 v248, s[32:35], s40 offen lds
    s_add_u32 m0, m0, 1024
    s_add_u32 s40, s40, 32768
    buffer_load_dwordx4 v248, s[32:35], s40 offen lds
    s_add_u32 m0, m0, 1024
    s_add_u32 s40, s40, 32768
    buffer_load_dwordx4 v248, s[32:35], s40 offen lds
    s_add_u32 m0, m0, 1024
    s_add_u32 s40, s40, 32768
    buffer_load_dwordx4 v248, s[32:35], s40 offen lds
    s_add_u32 m0, m0, 1024
    s_add_u32 s40, s40, 32768
    buffer_load_dwordx4 v248, s[32:35], s40 offen lds
    s_add_u32 m0, m0, 1024
    s_add_u32 s40, s40, 32768
    buffer_load_dwordx4 v248, s[32:35], s40 offen lds
    s_add_u32 m0, m0, 1024
    s_add_u32 s40, s40, 32768
    buffer_load_dwordx4 v248, s[32:35], s40 offen lds
    v_and_b32 v249, 1, v0
    v_bfe_u32 v250, v0, 1, 1
    v_lshrrev_b32 v251, 2, v21
    v_and_b32 v252, 1, v20
    v_lshl_or_b32 v252, v252, 1, v249
    v_lshlrev_b32 v252, 4, v252
    v_lshl_add_u32 v252, v250, 3, v252
    v_lshrrev_b32 v253, 1, v20
    v_lshl_add_u32 v254, v253, 3, v251
    v_lshl_add_u32 v254, v254, 8, v252
    v_lshl_add_u32 v255, v253, 2, v251
    v_lshl_add_u32 v255, v255, 8, v252
    v_xor_b32 v249, 0, v251
    v_lshl_add_u32 v9, v249, 6, v254
    v_xor_b32 v249, 1, v251
    v_lshl_add_u32 v10, v249, 6, v254
    v_xor_b32 v249, 2, v251
    v_lshl_add_u32 v11, v249, 6, v254
    v_xor_b32 v249, 3, v251
    v_lshl_add_u32 v12, v249, 6, v254
    v_mov_b32 v16, v255
    v_mov_b32 v17, v251
    v_add_u32 v249, 0, v19
    v_xor_b32 v249, v249, v21
    v_lshlrev_b32 v249, 4, v249
    v_lshl_add_u32 v1, v18, 8, v249
    v_add_u32 v249, 2, v19
    v_xor_b32 v249, v249, v21
    v_lshlrev_b32 v249, 4, v249
    v_lshl_add_u32 v2, v18, 8, v249
    v_add_u32 v249, 4, v19
    v_xor_b32 v249, v249, v21
    v_lshlrev_b32 v249, 4, v249
    v_lshl_add_u32 v3, v18, 8, v249
    v_add_u32 v249, 6, v19
    v_xor_b32 v249, v249, v21
    v_lshlrev_b32 v249, 4, v249
    v_lshl_add_u32 v4, v18, 8, v249
    v_add_u32 v249, 8, v19
    v_xor_b32 v249, v249, v21
    v_lshlrev_b32 v249, 4, v249
    v_lshl_add_u32 v5, v18, 8, v249
    v_add_u32 v249, 10, v19
    v_xor_b32 v249, v249, v21
    v_lshlrev_b32 v249, 4, v249
    v_lshl_add_u32 v6, v18, 8, v249
    v_add_u32 v249, 12, v19
    v_xor_b32 v249, v249, v21
    v_lshlrev_b32 v249, 4, v249
    v_lshl_add_u32 v7, v18, 8, v249
    v_add_u32 v249, 14, v19
    v_xor_b32 v249, v249, v21
    v_lshlrev_b32 v249, 4, v249
    v_lshl_add_u32 v8, v18, 8, v249
    s_mov_b32 s44, 0x3e0293ee
    v_add_u32 v1, s47, v1
    v_add_u32 v2, s47, v2
    v_add_u32 v3, s47, v3
    v_add_u32 v4, s47, v4
    v_add_u32 v5, s47, v5
    v_add_u32 v6, s47, v6
    v_add_u32 v7, s47, v7
    v_add_u32 v8, s47, v8
    s_waitcnt vmcnt(48)
    ds_read_b128 v[24:27], v1 offset:0
    ds_read_b128 v[28:31], v2 offset:0
    ds_read_b128 v[32:35], v3 offset:0
    ds_read_b128 v[36:39], v4 offset:0
    ds_read_b128 v[40:43], v5 offset:0
    ds_read_b128 v[44:47], v6 offset:0
    ds_read_b128 v[48:51], v7 offset:0
    ds_read_b128 v[52:55], v8 offset:0
    s_waitcnt vmcnt(40)
    ds_read_b128 v[56:59], v1 offset:8192
    ds_read_b128 v[60:63], v2 offset:8192
    ds_read_b128 v[64:67], v3 offset:8192
    ds_read_b128 v[68:71], v4 offset:8192
    ds_read_b128 v[72:75], v5 offset:8192
    ds_read_b128 v[76:79], v6 offset:8192
    ds_read_b128 v[80:83], v7 offset:8192
    ds_read_b128 v[84:87], v8 offset:8192
    s_waitcnt vmcnt(32)
    ds_read_b128 v[88:91], v1 offset:16384
    ds_read_b128 v[92:95], v2 offset:16384
    ds_read_b128 v[96:99], v3 offset:16384
    ds_read_b128 v[100:103], v4 offset:16384
    ds_read_b128 v[104:107], v5 offset:16384
    ds_read_b128 v[108:111], v6 offset:16384
    ds_read_b128 v[112:115], v7 offset:16384
    ds_read_b128 v[116:119], v8 offset:16384
    s_waitcnt vmcnt(24)
    ds_read_b128 v[120:123], v1 offset:24576
    ds_read_b128 v[124:127], v2 offset:24576
    ds_read_b128 v[128:131], v3 offset:24576
    ds_read_b128 v[132:135], v4 offset:24576
    ds_read_b128 v[136:139], v5 offset:24576
    ds_read_b128 v[140:143], v6 offset:24576
    ds_read_b128 v[144:147], v7 offset:24576
    ds_read_b128 v[148:151], v8 offset:24576
    s_waitcnt vmcnt(16)
    ds_read_b128 v[152:155], v1 offset:32768
    ds_read_b128 v[156:159], v2 offset:32768
    ds_read_b128 v[160:163], v3 offset:32768
    ds_read_b128 v[164:167], v4 offset:32768
    ds_read_b128 v[168:171], v5 offset:32768
    ds_read_b128 v[172:175], v6 offset:32768
    ds_read_b128 v[176:179], v7 offset:32768
    ds_read_b128 v[180:183], v8 offset:32768
    s_waitcnt lgkmcnt(0)
    v_subrev_u32 v1, s47, v1
    v_subrev_u32 v2, s47, v2
    v_subrev_u32 v3, s47, v3
    v_subrev_u32 v4, s47, v4
    v_subrev_u32 v5, s47, v5
    v_subrev_u32 v6, s47, v6
    v_subrev_u32 v7, s47, v7
    v_subrev_u32 v8, s47, v8
    s_mul_i32 s46, s16, 5
    s_add_u32 s46, s46, 5
    s_lshl_b32 m0, s46, 13
    s_add_u32 s40, s46, s45
    s_cmp_ge_u32 s40, 20
    s_cselect_b32 s41, 20, 0
    s_sub_u32 s40, s40, s41
    s_lshl_b32 s40, s40, 18
    s_add_u32 s46, s46, 1
    buffer_load_dwordx4 v248, s[32:35], s40 offen lds
    s_add_u32 m0, m0, 1024
    s_add_u32 s40, s40, 32768
    buffer_load_dwordx4 v248, s[32:35], s40 offen lds
    s_add_u32 m0, m0, 1024
    s_add_u32 s40, s40, 32768
    buffer_load_dwordx4 v248, s[32:35], s40 offen lds
    s_add_u32 m0, m0, 1024
    s_add_u32 s40, s40, 32768
    buffer_load_dwordx4 v248, s[32:35], s40 offen lds
    s_add_u32 m0, m0, 1024
    s_add_u32 s40, s40, 32768
    buffer_load_dwordx4 v248, s[32:35], s40 offen lds
    s_add_u32 m0, m0, 1024
    s_add_u32 s40, s40, 32768
    buffer_load_dwordx4 v248, s[32:35], s40 offen lds
    s_add_u32 m0, m0, 1024
    s_add_u32 s40, s40, 32768
    buffer_load_dwordx4 v248, s[32:35], s40 offen lds
    s_add_u32 m0, m0, 1024
    s_add_u32 s40, s40, 32768
    buffer_load_dwordx4 v248, s[32:35], s40 offen lds
    s_lshl_b32 m0, s46, 13
    s_add_u32 s40, s46, s45
    s_cmp_ge_u32 s40, 20
    s_cselect_b32 s41, 20, 0
    s_sub_u32 s40, s40, s41
    s_lshl_b32 s40, s40, 18
    s_add_u32 s46, s46, 1
    buffer_load_dwordx4 v248, s[32:35], s40 offen lds
    s_add_u32 m0, m0, 1024
    s_add_u32 s40, s40, 32768
    buffer_load_dwordx4 v248, s[32:35], s40 offen lds
    s_add_u32 m0, m0, 1024
    s_add_u32 s40, s40, 32768
    buffer_load_dwordx4 v248, s[32:35], s40 offen lds
    s_add_u32 m0, m0, 1024
    s_add_u32 s40, s40, 32768
    buffer_load_dwordx4 v248, s[32:35], s40 offen lds
    s_add_u32 m0, m0, 1024
    s_add_u32 s40, s40, 32768
    buffer_load_dwordx4 v248, s[32:35], s40 offen lds
    s_add_u32 m0, m0, 1024
    s_add_u32 s40, s40, 32768
    buffer_load_dwordx4 v248, s[32:35], s40 offen lds
    s_add_u32 m0, m0, 1024
    s_add_u32 s40, s40, 32768
    buffer_load_dwordx4 v248, s[32:35], s40 offen lds
    s_add_u32 m0, m0, 1024
    s_add_u32 s40, s40, 32768
    buffer_load_dwordx4 v248, s[32:35], s40 offen lds
    s_lshl_b32 m0, s46, 13
    s_add_u32 s40, s46, s45
    s_cmp_ge_u32 s40, 20
    s_cselect_b32 s41, 20, 0
    s_sub_u32 s40, s40, s41
    s_lshl_b32 s40, s40, 18
    s_add_u32 s46, s46, 1
    buffer_load_dwordx4 v248, s[32:35], s40 offen lds
    s_add_u32 m0, m0, 1024
    s_add_u32 s40, s40, 32768
    buffer_load_dwordx4 v248, s[32:35], s40 offen lds
    s_add_u32 m0, m0, 1024
    s_add_u32 s40, s40, 32768
    buffer_load_dwordx4 v248, s[32:35], s40 offen lds
    s_add_u32 m0, m0, 1024
    s_add_u32 s40, s40, 32768
    buffer_load_dwordx4 v248, s[32:35], s40 offen lds
    s_add_u32 m0, m0, 1024
    s_add_u32 s40, s40, 32768
    buffer_load_dwordx4 v248, s[32:35], s40 offen lds
    s_add_u32 m0, m0, 1024
    s_add_u32 s40, s40, 32768
    buffer_load_dwordx4 v248, s[32:35], s40 offen lds
    s_add_u32 m0, m0, 1024
    s_add_u32 s40, s40, 32768
    buffer_load_dwordx4 v248, s[32:35], s40 offen lds
    s_add_u32 m0, m0, 1024
    s_add_u32 s40, s40, 32768
    buffer_load_dwordx4 v248, s[32:35], s40 offen lds
    s_lshl_b32 m0, s46, 13
    s_add_u32 s40, s46, s45
    s_cmp_ge_u32 s40, 20
    s_cselect_b32 s41, 20, 0
    s_sub_u32 s40, s40, s41
    s_lshl_b32 s40, s40, 18
    s_add_u32 s46, s46, 1
    buffer_load_dwordx4 v248, s[32:35], s40 offen lds
    s_add_u32 m0, m0, 1024
    s_add_u32 s40, s40, 32768
    buffer_load_dwordx4 v248, s[32:35], s40 offen lds
    s_add_u32 m0, m0, 1024
    s_add_u32 s40, s40, 32768
    buffer_load_dwordx4 v248, s[32:35], s40 offen lds
    s_add_u32 m0, m0, 1024
    s_add_u32 s40, s40, 32768
    buffer_load_dwordx4 v248, s[32:35], s40 offen lds
    s_add_u32 m0, m0, 1024
    s_add_u32 s40, s40, 32768
    buffer_load_dwordx4 v248, s[32:35], s40 offen lds
    s_add_u32 m0, m0, 1024
    s_add_u32 s40, s40, 32768
    buffer_load_dwordx4 v248, s[32:35], s40 offen lds
    s_add_u32 m0, m0, 1024
    s_add_u32 s40, s40, 32768
    buffer_load_dwordx4 v248, s[32:35], s40 offen lds
    s_add_u32 m0, m0, 1024
    s_add_u32 s40, s40, 32768
    buffer_load_dwordx4 v248, s[32:35], s40 offen lds
    s_lshl_b32 m0, s46, 13
    s_add_u32 s40, s46, s45
    s_cmp_ge_u32 s40, 20
    s_cselect_b32 s41, 20, 0
    s_sub_u32 s40, s40, s41
    s_lshl_b32 s40, s40, 18
    s_add_u32 s46, s46, 1
    buffer_load_dwordx4 v248, s[32:35], s40 offen lds
    s_add_u32 m0, m0, 1024
    s_add_u32 s40, s40, 32768
    buffer_load_dwordx4 v248, s[32:35], s40 offen lds
    s_add_u32 m0, m0, 1024
    s_add_u32 s40, s40, 32768
    buffer_load_dwordx4 v248, s[32:35], s40 offen lds
    s_add_u32 m0, m0, 1024
    s_add_u32 s40, s40, 32768
    buffer_load_dwordx4 v248, s[32:35], s40 offen lds
    s_add_u32 m0, m0, 1024
    s_add_u32 s40, s40, 32768
    buffer_load_dwordx4 v248, s[32:35], s40 offen lds
    s_add_u32 m0, m0, 1024
    s_add_u32 s40, s40, 32768
    buffer_load_dwordx4 v248, s[32:35], s40 offen lds
    s_add_u32 m0, m0, 1024
    s_add_u32 s40, s40, 32768
    buffer_load_dwordx4 v248, s[32:35], s40 offen lds
    s_add_u32 m0, m0, 1024
    s_add_u32 s40, s40, 32768
    buffer_load_dwordx4 v248, s[32:35], s40 offen lds
    s_waitcnt vmcnt(40)
    s_barrier
    ds_read_b64_tr_b16 a[128:129], v9 offset:0
    ds_read_b64_tr_b16 a[130:131], v9 offset:1024
    ds_read_b64_tr_b16 a[132:133], v10 offset:0
    ds_read_b64_tr_b16 a[134:135], v10 offset:1024
    ds_read_b64_tr_b16 a[136:137], v11 offset:0
    ds_read_b64_tr_b16 a[138:139], v11 offset:1024
    ds_read_b64_tr_b16 a[140:141], v12 offset:0
    ds_read_b64_tr_b16 a[142:143], v12 offset:1024
    ds_read_b64_tr_b16 a[144:145], v9 offset:4096
    ds_read_b64_tr_b16 a[146:147], v9 offset:5120
    ds_read_b64_tr_b16 a[148:149], v10 offset:4096
    ds_read_b64_tr_b16 a[150:151], v10 offset:5120
    ds_read_b64_tr_b16 a[152:153], v11 offset:4096
    ds_read_b64_tr_b16 a[154:155], v11 offset:5120
    ds_read_b64_tr_b16 a[156:157], v12 offset:4096
    ds_read_b64_tr_b16 a[158:159], v12 offset:5120
    s_waitcnt lgkmcnt(14)
    v_mfma_f32_32x32x16_bf16 v[184:199], a[128:131], v[24:27], 0
    ds_read_b64_tr_b16 a[160:161], v9 offset:8192
    ds_read_b64_tr_b16 a[162:163], v9 offset:9216
    ds_read_b64_tr_b16 a[164:165], v10 offset:8192
    ds_read_b64_tr_b16 a[166:167], v10 offset:9216
    s_waitcnt lgkmcnt(15)
    v_mfma_f32_32x32x16_bf16 v[200:215], a[132:135], v[24:27], 0
    ds_read_b64_tr_b16 a[168:169], v11 offset:8192
    ds_read_b64_tr_b16 a[170:171], v11 offset:9216
    ds_read_b64_tr_b16 a[172:173], v12 offset:8192
    ds_read_b64_tr_b16 a[174:175], v12 offset:9216
    s_waitcnt lgkmcnt(15)
    v_mfma_f32_32x32x16_bf16 v[216:231], a[136:139], v[24:27], 0
    ds_read_b64_tr_b16 a[176:177], v9 offset:12288
    ds_read_b64_tr_b16 a[178:179], v9 offset:13312
    ds_read_b64_tr_b16 a[180:181], v10 offset:12288
    ds_read_b64_tr_b16 a[182:183], v10 offset:13312
    v_mfma_f32_32x32x16_bf16 v[232:247], a[140:143], v[24:27], 0
    ds_read_b64_tr_b16 a[184:185], v11 offset:12288
    ds_read_b64_tr_b16 a[186:187], v11 offset:13312
    ds_read_b64_tr_b16 a[188:189], v12 offset:12288
    ds_read_b64_tr_b16 a[190:191], v12 offset:13312
    s_waitcnt lgkmcnt(15)
    v_mfma_f32_32x32x16_bf16 v[184:199], a[144:147], v[28:31], v[184:199]
    v_mfma_f32_32x32x16_bf16 v[200:215], a[148:151], v[28:31], v[200:215]
    v_mfma_f32_32x32x16_bf16 v[216:231], a[152:155], v[28:31], v[216:231]
    v_mfma_f32_32x32x16_bf16 v[232:247], a[156:159], v[28:31], v[232:247]
    s_waitcnt lgkmcnt(14)
    v_mfma_f32_32x32x16_bf16 v[184:199], a[160:163], v[32:35], v[184:199]
    ds_read_b64_tr_b16 a[128:129], v9 offset:16384
    ds_read_b64_tr_b16 a[130:131], v9 offset:17408
    ds_read_b64_tr_b16 a[132:133], v10 offset:16384
    ds_read_b64_tr_b16 a[134:135], v10 offset:17408
    s_waitcnt lgkmcnt(15)
    v_mfma_f32_32x32x16_bf16 v[200:215], a[164:167], v[32:35], v[200:215]
    ds_read_b64_tr_b16 a[136:137], v11 offset:16384
    ds_read_b64_tr_b16 a[138:139], v11 offset:17408
    ds_read_b64_tr_b16 a[140:141], v12 offset:16384
    ds_read_b64_tr_b16 a[142:143], v12 offset:17408
    s_waitcnt lgkmcnt(15)
    v_mfma_f32_32x32x16_bf16 v[216:231], a[168:171], v[32:35], v[216:231]
    ds_read_b64_tr_b16 a[144:145], v9 offset:20480
    ds_read_b64_tr_b16 a[146:147], v9 offset:21504
    ds_read_b64_tr_b16 a[148:149], v10 offset:20480
    ds_read_b64_tr_b16 a[150:151], v10 offset:21504
    v_mfma_f32_32x32x16_bf16 v[232:247], a[172:175], v[32:35], v[232:247]
    ds_read_b64_tr_b16 a[152:153], v11 offset:20480
    ds_read_b64_tr_b16 a[154:155], v11 offset:21504
    ds_read_b64_tr_b16 a[156:157], v12 offset:20480
    ds_read_b64_tr_b16 a[158:159], v12 offset:21504
    s_waitcnt lgkmcnt(15)
    v_mfma_f32_32x32x16_bf16 v[184:199], a[176:179], v[36:39], v[184:199]
    v_mfma_f32_32x32x16_bf16 v[200:215], a[180:183], v[36:39], v[200:215]
    v_mfma_f32_32x32x16_bf16 v[216:231], a[184:187], v[36:39], v[216:231]
    v_mfma_f32_32x32x16_bf16 v[232:247], a[188:191], v[36:39], v[232:247]
    s_waitcnt lgkmcnt(14)
    v_mfma_f32_32x32x16_bf16 v[184:199], a[128:131], v[40:43], v[184:199]
    ds_read_b64_tr_b16 a[160:161], v9 offset:24576
    ds_read_b64_tr_b16 a[162:163], v9 offset:25600
    ds_read_b64_tr_b16 a[164:165], v10 offset:24576
    ds_read_b64_tr_b16 a[166:167], v10 offset:25600
    s_waitcnt lgkmcnt(15)
    v_mfma_f32_32x32x16_bf16 v[200:215], a[132:135], v[40:43], v[200:215]
    ds_read_b64_tr_b16 a[168:169], v11 offset:24576
    ds_read_b64_tr_b16 a[170:171], v11 offset:25600
    ds_read_b64_tr_b16 a[172:173], v12 offset:24576
    ds_read_b64_tr_b16 a[174:175], v12 offset:25600
    s_waitcnt lgkmcnt(15)
    v_mfma_f32_32x32x16_bf16 v[216:231], a[136:139], v[40:43], v[216:231]
    ds_read_b64_tr_b16 a[176:177], v9 offset:28672
    ds_read_b64_tr_b16 a[178:179], v9 offset:29696
    ds_read_b64_tr_b16 a[180:181], v10 offset:28672
    ds_read_b64_tr_b16 a[182:183], v10 offset:29696
    v_mfma_f32_32x32x16_bf16 v[232:247], a[140:143], v[40:43], v[232:247]
    ds_read_b64_tr_b16 a[184:185], v11 offset:28672
    ds_read_b64_tr_b16 a[186:187], v11 offset:29696
    ds_read_b64_tr_b16 a[188:189], v12 offset:28672
    ds_read_b64_tr_b16 a[190:191], v12 offset:29696
    s_waitcnt lgkmcnt(15)
    v_mfma_f32_32x32x16_bf16 v[184:199], a[144:147], v[44:47], v[184:199]
    v_mfma_f32_32x32x16_bf16 v[200:215], a[148:151], v[44:47], v[200:215]
    v_mfma_f32_32x32x16_bf16 v[216:231], a[152:155], v[44:47], v[216:231]
    v_mfma_f32_32x32x16_bf16 v[232:247], a[156:159], v[44:47], v[232:247]
    s_waitcnt lgkmcnt(14)
    v_mfma_f32_32x32x16_bf16 v[184:199], a[160:163], v[48:51], v[184:199]
    ds_read_b64_tr_b16 a[128:129], v9 offset:32768
    ds_read_b64_tr_b16 a[130:131], v9 offset:33792
    ds_read_b64_tr_b16 a[132:133], v10 offset:32768
    ds_read_b64_tr_b16 a[134:135], v10 offset:33792
    s_waitcnt lgkmcnt(15)
    v_mfma_f32_32x32x16_bf16 v[200:215], a[164:167], v[48:51], v[200:215]
    ds_read_b64_tr_b16 a[136:137], v11 offset:32768
    ds_read_b64_tr_b16 a[138:139], v11 offset:33792
    ds_read_b64_tr_b16 a[140:141], v12 offset:32768
    ds_read_b64_tr_b16 a[142:143], v12 offset:33792
    s_waitcnt lgkmcnt(15)
    v_mfma_f32_32x32x16_bf16 v[216:231], a[168:171], v[48:51], v[216:231]
    ds_read_b64_tr_b16 a[144:145], v9 offset:36864
    ds_read_b64_tr_b16 a[146:147], v9 offset:37888
    ds_read_b64_tr_b16 a[148:149], v10 offset:36864
    ds_read_b64_tr_b16 a[150:151], v10 offset:37888
    v_mfma_f32_32x32x16_bf16 v[232:247], a[172:175], v[48:51], v[232:247]
    ds_read_b64_tr_b16 a[152:153], v11 offset:36864
    ds_read_b64_tr_b16 a[154:155], v11 offset:37888
    ds_read_b64_tr_b16 a[156:157], v12 offset:36864
    ds_read_b64_tr_b16 a[158:159], v12 offset:37888
    s_waitcnt lgkmcnt(15)
    v_mfma_f32_32x32x16_bf16 v[184:199], a[176:179], v[52:55], v[184:199]
    v_mfma_f32_32x32x16_bf16 v[200:215], a[180:183], v[52:55], v[200:215]
    v_mfma_f32_32x32x16_bf16 v[216:231], a[184:187], v[52:55], v[216:231]
    v_mfma_f32_32x32x16_bf16 v[232:247], a[188:191], v[52:55], v[232:247]
    s_waitcnt lgkmcnt(14)
    v_mfma_f32_32x32x16_bf16 v[184:199], a[128:131], v[56:59], v[184:199]
    s_waitcnt lgkmcnt(12)
    v_mfma_f32_32x32x16_bf16 v[200:215], a[132:135], v[56:59], v[200:215]
    s_waitcnt lgkmcnt(10)
    v_mfma_f32_32x32x16_bf16 v[216:231], a[136:139], v[56:59], v[216:231]
    s_waitcnt vmcnt(0)
    s_waitcnt lgkmcnt(0)
    s_barrier
    v_mfma_f32_32x32x16_bf16 v[232:247], a[140:143], v[56:59], v[232:247]
    ds_read_b64_tr_b16 a[160:161], v9 offset:40960
    ds_read_b64_tr_b16 a[162:163], v9 offset:41984
    ds_read_b64_tr_b16 a[164:165], v10 offset:40960
    ds_read_b64_tr_b16 a[166:167], v10 offset:41984
    v_mfma_f32_32x32x16_bf16 v[184:199], a[144:147], v[60:63], v[184:199]
    ds_read_b64_tr_b16 a[168:169], v11 offset:40960
    ds_read_b64_tr_b16 a[170:171], v11 offset:41984
    ds_read_b64_tr_b16 a[172:173], v12 offset:40960
    ds_read_b64_tr_b16 a[174:175], v12 offset:41984
    v_mfma_f32_32x32x16_bf16 v[200:215], a[148:151], v[60:63], v[200:215]
    ds_read_b64_tr_b16 a[176:177], v9 offset:45056
    ds_read_b64_tr_b16 a[178:179], v9 offset:46080
    ds_read_b64_tr_b16 a[180:181], v10 offset:45056
    ds_read_b64_tr_b16 a[182:183], v10 offset:46080
    v_mfma_f32_32x32x16_bf16 v[216:231], a[152:155], v[60:63], v[216:231]
    ds_read_b64_tr_b16 a[184:185], v11 offset:45056
    ds_read_b64_tr_b16 a[186:187], v11 offset:46080
    ds_read_b64_tr_b16 a[188:189], v12 offset:45056
    ds_read_b64_tr_b16 a[190:191], v12 offset:46080
    v_mfma_f32_32x32x16_bf16 v[232:247], a[156:159], v[60:63], v[232:247]
    s_waitcnt lgkmcnt(14)
    v_mfma_f32_32x32x16_bf16 v[184:199], a[160:163], v[64:67], v[184:199]
    ds_read_b64_tr_b16 a[128:129], v9 offset:49152
    ds_read_b64_tr_b16 a[130:131], v9 offset:50176
    ds_read_b64_tr_b16 a[132:133], v10 offset:49152
    ds_read_b64_tr_b16 a[134:135], v10 offset:50176
    s_waitcnt lgkmcnt(15)
    v_mfma_f32_32x32x16_bf16 v[200:215], a[164:167], v[64:67], v[200:215]
    ds_read_b64_tr_b16 a[136:137], v11 offset:49152
    ds_read_b64_tr_b16 a[138:139], v11 offset:50176
    ds_read_b64_tr_b16 a[140:141], v12 offset:49152
    ds_read_b64_tr_b16 a[142:143], v12 offset:50176
    s_waitcnt lgkmcnt(15)
    v_mfma_f32_32x32x16_bf16 v[216:231], a[168:171], v[64:67], v[216:231]
    ds_read_b64_tr_b16 a[144:145], v9 offset:53248
    ds_read_b64_tr_b16 a[146:147], v9 offset:54272
    ds_read_b64_tr_b16 a[148:149], v10 offset:53248
    ds_read_b64_tr_b16 a[150:151], v10 offset:54272
    v_mfma_f32_32x32x16_bf16 v[232:247], a[172:175], v[64:67], v[232:247]
    ds_read_b64_tr_b16 a[152:153], v11 offset:53248
    ds_read_b64_tr_b16 a[154:155], v11 offset:54272
    ds_read_b64_tr_b16 a[156:157], v12 offset:53248
    ds_read_b64_tr_b16 a[158:159], v12 offset:54272
    s_waitcnt lgkmcnt(15)
    v_mfma_f32_32x32x16_bf16 v[184:199], a[176:179], v[68:71], v[184:199]
    v_mfma_f32_32x32x16_bf16 v[200:215], a[180:183], v[68:71], v[200:215]
    v_mfma_f32_32x32x16_bf16 v[216:231], a[184:187], v[68:71], v[216:231]
    v_mfma_f32_32x32x16_bf16 v[232:247], a[188:191], v[68:71], v[232:247]
    s_waitcnt lgkmcnt(14)
    v_mfma_f32_32x32x16_bf16 v[184:199], a[128:131], v[72:75], v[184:199]
    ds_read_b64_tr_b16 a[160:161], v9 offset:57344
    ds_read_b64_tr_b16 a[162:163], v9 offset:58368
    ds_read_b64_tr_b16 a[164:165], v10 offset:57344
    ds_read_b64_tr_b16 a[166:167], v10 offset:58368
    s_waitcnt lgkmcnt(15)
    v_mfma_f32_32x32x16_bf16 v[200:215], a[132:135], v[72:75], v[200:215]
    ds_read_b64_tr_b16 a[168:169], v11 offset:57344
    ds_read_b64_tr_b16 a[170:171], v11 offset:58368
    ds_read_b64_tr_b16 a[172:173], v12 offset:57344
    ds_read_b64_tr_b16 a[174:175], v12 offset:58368
    s_waitcnt lgkmcnt(15)
    v_mfma_f32_32x32x16_bf16 v[216:231], a[136:139], v[72:75], v[216:231]
    ds_read_b64_tr_b16 a[176:177], v9 offset:61440
    ds_read_b64_tr_b16 a[178:179], v9 offset:62464
    ds_read_b64_tr_b16 a[180:181], v10 offset:61440
    ds_read_b64_tr_b16 a[182:183], v10 offset:62464
    v_mfma_f32_32x32x16_bf16 v[232:247], a[140:143], v[72:75], v[232:247]
    ds_read_b64_tr_b16 a[184:185], v11 offset:61440
    ds_read_b64_tr_b16 a[186:187], v11 offset:62464
    ds_read_b64_tr_b16 a[188:189], v12 offset:61440
    ds_read_b64_tr_b16 a[190:191], v12 offset:62464
    s_waitcnt lgkmcnt(15)
    v_mfma_f32_32x32x16_bf16 v[184:199], a[144:147], v[76:79], v[184:199]
    v_mfma_f32_32x32x16_bf16 v[200:215], a[148:151], v[76:79], v[200:215]
    v_mfma_f32_32x32x16_bf16 v[216:231], a[152:155], v[76:79], v[216:231]
    v_mfma_f32_32x32x16_bf16 v[232:247], a[156:159], v[76:79], v[232:247]
    s_waitcnt lgkmcnt(14)
    v_mfma_f32_32x32x16_bf16 v[184:199], a[160:163], v[80:83], v[184:199]
    v_add_u32 v9, 0x10000, v9
    v_add_u32 v10, 0x10000, v10
    v_add_u32 v11, 0x10000, v11
    v_add_u32 v12, 0x10000, v12
    ds_read_b64_tr_b16 a[128:129], v9 offset:0
    s_waitcnt lgkmcnt(13)
    v_mfma_f32_32x32x16_bf16 v[200:215], a[164:167], v[80:83], v[200:215]
    ds_read_b64_tr_b16 a[130:131], v9 offset:1024
    ds_read_b64_tr_b16 a[132:133], v10 offset:0
    ds_read_b64_tr_b16 a[134:135], v10 offset:1024
    ds_read_b64_tr_b16 a[136:137], v11 offset:0
    ds_read_b64_tr_b16 a[138:139], v11 offset:1024
    s_waitcnt lgkmcnt(15)
    v_mfma_f32_32x32x16_bf16 v[216:231], a[168:171], v[80:83], v[216:231]
    ds_read_b64_tr_b16 a[140:141], v12 offset:0
    ds_read_b64_tr_b16 a[142:143], v12 offset:1024
    ds_read_b64_tr_b16 a[144:145], v9 offset:4096
    ds_read_b64_tr_b16 a[146:147], v9 offset:5120
    ds_read_b64_tr_b16 a[148:149], v10 offset:4096
    s_waitcnt lgkmcnt(15)
    v_mfma_f32_32x32x16_bf16 v[232:247], a[172:175], v[80:83], v[232:247]
    ds_read_b64_tr_b16 a[150:151], v10 offset:5120
    ds_read_b64_tr_b16 a[152:153], v11 offset:4096
    ds_read_b64_tr_b16 a[154:155], v11 offset:5120
    ds_read_b64_tr_b16 a[156:157], v12 offset:4096
    ds_read_b64_tr_b16 a[158:159], v12 offset:5120
    v_mfma_f32_32x32x16_bf16 v[184:199], a[176:179], v[84:87], v[184:199]
    v_mfma_f32_32x32x16_bf16 v[200:215], a[180:183], v[84:87], v[200:215]
    s_waitcnt lgkmcnt(15)
    v_mfma_f32_32x32x16_bf16 v[216:231], a[184:187], v[84:87], v[216:231]
    v_mfma_f32_32x32x16_bf16 v[232:247], a[188:191], v[84:87], v[232:247]
    s_waitcnt lgkmcnt(14)
    v_mfma_f32_32x32x16_bf16 v[184:199], a[128:131], v[88:91], v[184:199]
    ds_read_b64_tr_b16 a[160:161], v9 offset:8192
    ds_read_b64_tr_b16 a[162:163], v9 offset:9216
    ds_read_b64_tr_b16 a[164:165], v10 offset:8192
    ds_read_b64_tr_b16 a[166:167], v10 offset:9216
    s_waitcnt lgkmcnt(15)
    v_mfma_f32_32x32x16_bf16 v[200:215], a[132:135], v[88:91], v[200:215]
    ds_read_b64_tr_b16 a[168:169], v11 offset:8192
    ds_read_b64_tr_b16 a[170:171], v11 offset:9216
    ds_read_b64_tr_b16 a[172:173], v12 offset:8192
    ds_read_b64_tr_b16 a[174:175], v12 offset:9216
    s_waitcnt lgkmcnt(15)
    v_mfma_f32_32x32x16_bf16 v[216:231], a[136:139], v[88:91], v[216:231]
    ds_read_b64_tr_b16 a[176:177], v9 offset:12288
    ds_read_b64_tr_b16 a[178:179], v9 offset:13312
    ds_read_b64_tr_b16 a[180:181], v10 offset:12288
    ds_read_b64_tr_b16 a[182:183], v10 offset:13312
    v_mfma_f32_32x32x16_bf16 v[232:247], a[140:143], v[88:91], v[232:247]
    ds_read_b64_tr_b16 a[184:185], v11 offset:12288
    ds_read_b64_tr_b16 a[186:187], v11 offset:13312
    ds_read_b64_tr_b16 a[188:189], v12 offset:12288
    ds_read_b64_tr_b16 a[190:191], v12 offset:13312
    s_waitcnt lgkmcnt(15)
    v_mfma_f32_32x32x16_bf16 v[184:199], a[144:147], v[92:95], v[184:199]
    v_mfma_f32_32x32x16_bf16 v[200:215], a[148:151], v[92:95], v[200:215]
    v_mfma_f32_32x32x16_bf16 v[216:231], a[152:155], v[92:95], v[216:231]
    v_mfma_f32_32x32x16_bf16 v[232:247], a[156:159], v[92:95], v[232:247]
    s_waitcnt lgkmcnt(14)
    v_mfma_f32_32x32x16_bf16 v[184:199], a[160:163], v[96:99], v[184:199]
    ds_read_b64_tr_b16 a[128:129], v9 offset:16384
    ds_read_b64_tr_b16 a[130:131], v9 offset:17408
    ds_read_b64_tr_b16 a[132:133], v10 offset:16384
    ds_read_b64_tr_b16 a[134:135], v10 offset:17408
    s_waitcnt lgkmcnt(15)
    v_mfma_f32_32x32x16_bf16 v[200:215], a[164:167], v[96:99], v[200:215]
    ds_read_b64_tr_b16 a[136:137], v11 offset:16384
    ds_read_b64_tr_b16 a[138:139], v11 offset:17408
    ds_read_b64_tr_b16 a[140:141], v12 offset:16384
    ds_read_b64_tr_b16 a[142:143], v12 offset:17408
    s_waitcnt lgkmcnt(15)
    v_mfma_f32_32x32x16_bf16 v[216:231], a[168:171], v[96:99], v[216:231]
    ds_read_b64_tr_b16 a[144:145], v9 offset:20480
    ds_read_b64_tr_b16 a[146:147], v9 offset:21504
    ds_read_b64_tr_b16 a[148:149], v10 offset:20480
    ds_read_b64_tr_b16 a[150:151], v10 offset:21504
    v_mfma_f32_32x32x16_bf16 v[232:247], a[172:175], v[96:99], v[232:247]
    ds_read_b64_tr_b16 a[152:153], v11 offset:20480
    ds_read_b64_tr_b16 a[154:155], v11 offset:21504
    ds_read_b64_tr_b16 a[156:157], v12 offset:20480
    ds_read_b64_tr_b16 a[158:159], v12 offset:21504
    s_waitcnt lgkmcnt(15)
    v_mfma_f32_32x32x16_bf16 v[184:199], a[176:179], v[100:103], v[184:199]
    v_mfma_f32_32x32x16_bf16 v[200:215], a[180:183], v[100:103], v[200:215]
    v_mfma_f32_32x32x16_bf16 v[216:231], a[184:187], v[100:103], v[216:231]
    v_mfma_f32_32x32x16_bf16 v[232:247], a[188:191], v[100:103], v[232:247]
    s_waitcnt lgkmcnt(14)
    v_mfma_f32_32x32x16_bf16 v[184:199], a[128:131], v[104:107], v[184:199]
    ds_read_b64_tr_b16 a[160:161], v9 offset:24576
    ds_read_b64_tr_b16 a[162:163], v9 offset:25600
    ds_read_b64_tr_b16 a[164:165], v10 offset:24576
    ds_read_b64_tr_b16 a[166:167], v10 offset:25600
    s_waitcnt lgkmcnt(15)
    v_mfma_f32_32x32x16_bf16 v[200:215], a[132:135], v[104:107], v[200:215]
    ds_read_b64_tr_b16 a[168:169], v11 offset:24576
    ds_read_b64_tr_b16 a[170:171], v11 offset:25600
    ds_read_b64_tr_b16 a[172:173], v12 offset:24576
    ds_read_b64_tr_b16 a[174:175], v12 offset:25600
    s_waitcnt lgkmcnt(15)
    v_mfma_f32_32x32x16_bf16 v[216:231], a[136:139], v[104:107], v[216:231]
    ds_read_b64_tr_b16 a[176:177], v9 offset:28672
    ds_read_b64_tr_b16 a[178:179], v9 offset:29696
    ds_read_b64_tr_b16 a[180:181], v10 offset:28672
    ds_read_b64_tr_b16 a[182:183], v10 offset:29696
    v_mfma_f32_32x32x16_bf16 v[232:247], a[140:143], v[104:107], v[232:247]
    ds_read_b64_tr_b16 a[184:185], v11 offset:28672
    ds_read_b64_tr_b16 a[186:187], v11 offset:29696
    ds_read_b64_tr_b16 a[188:189], v12 offset:28672
    ds_read_b64_tr_b16 a[190:191], v12 offset:29696
    s_waitcnt lgkmcnt(15)
    v_mfma_f32_32x32x16_bf16 v[184:199], a[144:147], v[108:111], v[184:199]
    v_mfma_f32_32x32x16_bf16 v[200:215], a[148:151], v[108:111], v[200:215]
    v_mfma_f32_32x32x16_bf16 v[216:231], a[152:155], v[108:111], v[216:231]
    v_mfma_f32_32x32x16_bf16 v[232:247], a[156:159], v[108:111], v[232:247]
    s_waitcnt lgkmcnt(14)
    v_mfma_f32_32x32x16_bf16 v[184:199], a[160:163], v[112:115], v[184:199]
    ds_read_b64_tr_b16 a[128:129], v9 offset:32768
    ds_read_b64_tr_b16 a[130:131], v9 offset:33792
    ds_read_b64_tr_b16 a[132:133], v10 offset:32768
    ds_read_b64_tr_b16 a[134:135], v10 offset:33792
    s_waitcnt lgkmcnt(15)
    v_mfma_f32_32x32x16_bf16 v[200:215], a[164:167], v[112:115], v[200:215]
    ds_read_b64_tr_b16 a[136:137], v11 offset:32768
    ds_read_b64_tr_b16 a[138:139], v11 offset:33792
    ds_read_b64_tr_b16 a[140:141], v12 offset:32768
    ds_read_b64_tr_b16 a[142:143], v12 offset:33792
    s_waitcnt lgkmcnt(15)
    v_mfma_f32_32x32x16_bf16 v[216:231], a[168:171], v[112:115], v[216:231]
    ds_read_b64_tr_b16 a[144:145], v9 offset:36864
    ds_read_b64_tr_b16 a[146:147], v9 offset:37888
    ds_read_b64_tr_b16 a[148:149], v10 offset:36864
    ds_read_b64_tr_b16 a[150:151], v10 offset:37888
    v_mfma_f32_32x32x16_bf16 v[232:247], a[172:175], v[112:115], v[232:247]
    ds_read_b64_tr_b16 a[152:153], v11 offset:36864
    ds_read_b64_tr_b16 a[154:155], v11 offset:37888
    ds_read_b64_tr_b16 a[156:157], v12 offset:36864
    ds_read_b64_tr_b16 a[158:159], v12 offset:37888
    s_waitcnt lgkmcnt(15)
    v_mfma_f32_32x32x16_bf16 v[184:199], a[176:179], v[116:119], v[184:199]
    v_mfma_f32_32x32x16_bf16 v[200:215], a[180:183], v[116:119], v[200:215]
    v_mfma_f32_32x32x16_bf16 v[216:231], a[184:187], v[116:119], v[216:231]
    v_mfma_f32_32x32x16_bf16 v[232:247], a[188:191], v[116:119], v[232:247]
    s_waitcnt lgkmcnt(14)
    v_mfma_f32_32x32x16_bf16 v[184:199], a[128:131], v[120:123], v[184:199]
    ds_read_b64_tr_b16 a[160:161], v9 offset:40960
    ds_read_b64_tr_b16 a[162:163], v9 offset:41984
    ds_read_b64_tr_b16 a[164:165], v10 offset:40960
    ds_read_b64_tr_b16 a[166:167], v10 offset:41984
    s_waitcnt lgkmcnt(15)
    v_mfma_f32_32x32x16_bf16 v[200:215], a[132:135], v[120:123], v[200:215]
    ds_read_b64_tr_b16 a[168:169], v11 offset:40960
    ds_read_b64_tr_b16 a[170:171], v11 offset:41984
    ds_read_b64_tr_b16 a[172:173], v12 offset:40960
    ds_read_b64_tr_b16 a[174:175], v12 offset:41984
    s_waitcnt lgkmcnt(15)
    v_mfma_f32_32x32x16_bf16 v[216:231], a[136:139], v[120:123], v[216:231]
    ds_read_b64_tr_b16 a[176:177], v9 offset:45056
    ds_read_b64_tr_b16 a[178:179], v9 offset:46080
    ds_read_b64_tr_b16 a[180:181], v10 offset:45056
    ds_read_b64_tr_b16 a[182:183], v10 offset:46080
    v_mfma_f32_32x32x16_bf16 v[232:247], a[140:143], v[120:123], v[232:247]
    ds_read_b64_tr_b16 a[184:185], v11 offset:45056
    ds_read_b64_tr_b16 a[186:187], v11 offset:46080
    ds_read_b64_tr_b16 a[188:189], v12 offset:45056
    ds_read_b64_tr_b16 a[190:191], v12 offset:46080
    s_waitcnt lgkmcnt(15)
    v_mfma_f32_32x32x16_bf16 v[184:199], a[144:147], v[124:127], v[184:199]
    v_mfma_f32_32x32x16_bf16 v[200:215], a[148:151], v[124:127], v[200:215]
    v_mfma_f32_32x32x16_bf16 v[216:231], a[152:155], v[124:127], v[216:231]
    v_mfma_f32_32x32x16_bf16 v[232:247], a[156:159], v[124:127], v[232:247]
    s_waitcnt lgkmcnt(14)
    v_mfma_f32_32x32x16_bf16 v[184:199], a[160:163], v[128:131], v[184:199]
    ds_read_b64_tr_b16 a[128:129], v9 offset:49152
    ds_read_b64_tr_b16 a[130:131], v9 offset:50176
    ds_read_b64_tr_b16 a[132:133], v10 offset:49152
    ds_read_b64_tr_b16 a[134:135], v10 offset:50176
    s_waitcnt lgkmcnt(15)
    v_mfma_f32_32x32x16_bf16 v[200:215], a[164:167], v[128:131], v[200:215]
    ds_read_b64_tr_b16 a[136:137], v11 offset:49152
    ds_read_b64_tr_b16 a[138:139], v11 offset:50176
    ds_read_b64_tr_b16 a[140:141], v12 offset:49152
    ds_read_b64_tr_b16 a[142:143], v12 offset:50176
    s_waitcnt lgkmcnt(15)
    v_mfma_f32_32x32x16_bf16 v[216:231], a[168:171], v[128:131], v[216:231]
    ds_read_b64_tr_b16 a[144:145], v9 offset:53248
    ds_read_b64_tr_b16 a[146:147], v9 offset:54272
    ds_read_b64_tr_b16 a[148:149], v10 offset:53248
    ds_read_b64_tr_b16 a[150:151], v10 offset:54272
    v_mfma_f32_32x32x16_bf16 v[232:247], a[172:175], v[128:131], v[232:247]
    ds_read_b64_tr_b16 a[152:153], v11 offset:53248
    ds_read_b64_tr_b16 a[154:155], v11 offset:54272
    ds_read_b64_tr_b16 a[156:157], v12 offset:53248
    ds_read_b64_tr_b16 a[158:159], v12 offset:54272
    s_waitcnt lgkmcnt(15)
    v_mfma_f32_32x32x16_bf16 v[184:199], a[176:179], v[132:135], v[184:199]
    v_mfma_f32_32x32x16_bf16 v[200:215], a[180:183], v[132:135], v[200:215]
    v_mfma_f32_32x32x16_bf16 v[216:231], a[184:187], v[132:135], v[216:231]
    v_mfma_f32_32x32x16_bf16 v[232:247], a[188:191], v[132:135], v[232:247]
    s_waitcnt lgkmcnt(14)
    v_mfma_f32_32x32x16_bf16 v[184:199], a[128:131], v[136:139], v[184:199]
    ds_read_b64_tr_b16 a[160:161], v9 offset:57344
    ds_read_b64_tr_b16 a[162:163], v9 offset:58368
    ds_read_b64_tr_b16 a[164:165], v10 offset:57344
    ds_read_b64_tr_b16 a[166:167], v10 offset:58368
    s_waitcnt lgkmcnt(15)
    v_mfma_f32_32x32x16_bf16 v[200:215], a[132:135], v[136:139], v[200:215]
    ds_read_b64_tr_b16 a[168:169], v11 offset:57344
    ds_read_b64_tr_b16 a[170:171], v11 offset:58368
    ds_read_b64_tr_b16 a[172:173], v12 offset:57344
    ds_read_b64_tr_b16 a[174:175], v12 offset:58368
    s_waitcnt lgkmcnt(15)
    v_mfma_f32_32x32x16_bf16 v[216:231], a[136:139], v[136:139], v[216:231]
    ds_read_b64_tr_b16 a[176:177], v9 offset:61440
    ds_read_b64_tr_b16 a[178:179], v9 offset:62464
    ds_read_b64_tr_b16 a[180:181], v10 offset:61440
    ds_read_b64_tr_b16 a[182:183], v10 offset:62464
    v_mfma_f32_32x32x16_bf16 v[232:247], a[140:143], v[136:139], v[232:247]
    ds_read_b64_tr_b16 a[184:185], v11 offset:61440
    ds_read_b64_tr_b16 a[186:187], v11 offset:62464
    ds_read_b64_tr_b16 a[188:189], v12 offset:61440
    ds_read_b64_tr_b16 a[190:191], v12 offset:62464
    s_waitcnt lgkmcnt(15)
    v_mfma_f32_32x32x16_bf16 v[184:199], a[144:147], v[140:143], v[184:199]
    v_mfma_f32_32x32x16_bf16 v[200:215], a[148:151], v[140:143], v[200:215]
    v_mfma_f32_32x32x16_bf16 v[216:231], a[152:155], v[140:143], v[216:231]
    v_mfma_f32_32x32x16_bf16 v[232:247], a[156:159], v[140:143], v[232:247]
    s_waitcnt lgkmcnt(14)
    v_mfma_f32_32x32x16_bf16 v[184:199], a[160:163], v[144:147], v[184:199]
    v_add_u32 v9, 0x10000, v9
    v_add_u32 v10, 0x10000, v10
    v_add_u32 v11, 0x10000, v11
    v_add_u32 v12, 0x10000, v12
    ds_read_b64_tr_b16 a[128:129], v9 offset:0
    s_waitcnt lgkmcnt(13)
    v_mfma_f32_32x32x16_bf16 v[200:215], a[164:167], v[144:147], v[200:215]
    ds_read_b64_tr_b16 a[130:131], v9 offset:1024
    ds_read_b64_tr_b16 a[132:133], v10 offset:0
    ds_read_b64_tr_b16 a[134:135], v10 offset:1024
    ds_read_b64_tr_b16 a[136:137], v11 offset:0
    ds_read_b64_tr_b16 a[138:139], v11 offset:1024
    s_waitcnt lgkmcnt(15)
    v_mfma_f32_32x32x16_bf16 v[216:231], a[168:171], v[144:147], v[216:231]
    ds_read_b64_tr_b16 a[140:141], v12 offset:0
    ds_read_b64_tr_b16 a[142:143], v12 offset:1024
    ds_read_b64_tr_b16 a[144:145], v9 offset:4096
    ds_read_b64_tr_b16 a[146:147], v9 offset:5120
    ds_read_b64_tr_b16 a[148:149], v10 offset:4096
    s_waitcnt lgkmcnt(15)
    v_mfma_f32_32x32x16_bf16 v[232:247], a[172:175], v[144:147], v[232:247]
    ds_read_b64_tr_b16 a[150:151], v10 offset:5120
    ds_read_b64_tr_b16 a[152:153], v11 offset:4096
    ds_read_b64_tr_b16 a[154:155], v11 offset:5120
    ds_read_b64_tr_b16 a[156:157], v12 offset:4096
    ds_read_b64_tr_b16 a[158:159], v12 offset:5120
    v_mfma_f32_32x32x16_bf16 v[184:199], a[176:179], v[148:151], v[184:199]
    v_mfma_f32_32x32x16_bf16 v[200:215], a[180:183], v[148:151], v[200:215]
    s_waitcnt lgkmcnt(15)
    v_mfma_f32_32x32x16_bf16 v[216:231], a[184:187], v[148:151], v[216:231]
    v_mfma_f32_32x32x16_bf16 v[232:247], a[188:191], v[148:151], v[232:247]
    s_waitcnt lgkmcnt(14)
    v_mfma_f32_32x32x16_bf16 v[184:199], a[128:131], v[152:155], v[184:199]
    ds_read_b64_tr_b16 a[160:161], v9 offset:8192
    ds_read_b64_tr_b16 a[162:163], v9 offset:9216
    ds_read_b64_tr_b16 a[164:165], v10 offset:8192
    ds_read_b64_tr_b16 a[166:167], v10 offset:9216
    s_waitcnt lgkmcnt(15)
    v_mfma_f32_32x32x16_bf16 v[200:215], a[132:135], v[152:155], v[200:215]
    ds_read_b64_tr_b16 a[168:169], v11 offset:8192
    ds_read_b64_tr_b16 a[170:171], v11 offset:9216
    ds_read_b64_tr_b16 a[172:173], v12 offset:8192
    ds_read_b64_tr_b16 a[174:175], v12 offset:9216
    s_waitcnt lgkmcnt(15)
    v_mfma_f32_32x32x16_bf16 v[216:231], a[136:139], v[152:155], v[216:231]
    ds_read_b64_tr_b16 a[176:177], v9 offset:12288
    ds_read_b64_tr_b16 a[178:179], v9 offset:13312
    ds_read_b64_tr_b16 a[180:181], v10 offset:12288
    ds_read_b64_tr_b16 a[182:183], v10 offset:13312
    v_mfma_f32_32x32x16_bf16 v[232:247], a[140:143], v[152:155], v[232:247]
    ds_read_b64_tr_b16 a[184:185], v11 offset:12288
    ds_read_b64_tr_b16 a[186:187], v11 offset:13312
    ds_read_b64_tr_b16 a[188:189], v12 offset:12288
    ds_read_b64_tr_b16 a[190:191], v12 offset:13312
    s_waitcnt lgkmcnt(15)
    v_mfma_f32_32x32x16_bf16 v[184:199], a[144:147], v[156:159], v[184:199]
    v_mfma_f32_32x32x16_bf16 v[200:215], a[148:151], v[156:159], v[200:215]
    v_mfma_f32_32x32x16_bf16 v[216:231], a[152:155], v[156:159], v[216:231]
    v_mfma_f32_32x32x16_bf16 v[232:247], a[156:159], v[156:159], v[232:247]
    s_waitcnt lgkmcnt(14)
    v_mfma_f32_32x32x16_bf16 v[184:199], a[160:163], v[160:163], v[184:199]
    ds_read_b64_tr_b16 a[128:129], v9 offset:16384
    ds_read_b64_tr_b16 a[130:131], v9 offset:17408
    ds_read_b64_tr_b16 a[132:133], v10 offset:16384
    ds_read_b64_tr_b16 a[134:135], v10 offset:17408
    s_waitcnt lgkmcnt(15)
    v_mfma_f32_32x32x16_bf16 v[200:215], a[164:167], v[160:163], v[200:215]
    ds_read_b64_tr_b16 a[136:137], v11 offset:16384
    ds_read_b64_tr_b16 a[138:139], v11 offset:17408
    ds_read_b64_tr_b16 a[140:141], v12 offset:16384
    ds_read_b64_tr_b16 a[142:143], v12 offset:17408
    s_waitcnt lgkmcnt(15)
    v_mfma_f32_32x32x16_bf16 v[216:231], a[168:171], v[160:163], v[216:231]
    ds_read_b64_tr_b16 a[144:145], v9 offset:20480
    ds_read_b64_tr_b16 a[146:147], v9 offset:21504
    ds_read_b64_tr_b16 a[148:149], v10 offset:20480
    ds_read_b64_tr_b16 a[150:151], v10 offset:21504
    v_mfma_f32_32x32x16_bf16 v[232:247], a[172:175], v[160:163], v[232:247]
    ds_read_b64_tr_b16 a[152:153], v11 offset:20480
    ds_read_b64_tr_b16 a[154:155], v11 offset:21504
    ds_read_b64_tr_b16 a[156:157], v12 offset:20480
    ds_read_b64_tr_b16 a[158:159], v12 offset:21504
    s_waitcnt lgkmcnt(15)
    v_mfma_f32_32x32x16_bf16 v[184:199], a[176:179], v[164:167], v[184:199]
    v_mfma_f32_32x32x16_bf16 v[200:215], a[180:183], v[164:167], v[200:215]
    v_mfma_f32_32x32x16_bf16 v[216:231], a[184:187], v[164:167], v[216:231]
    v_mfma_f32_32x32x16_bf16 v[232:247], a[188:191], v[164:167], v[232:247]
    s_waitcnt lgkmcnt(14)
    v_mfma_f32_32x32x16_bf16 v[184:199], a[128:131], v[168:171], v[184:199]
    ds_read_b64_tr_b16 a[160:161], v9 offset:24576
    ds_read_b64_tr_b16 a[162:163], v9 offset:25600
    ds_read_b64_tr_b16 a[164:165], v10 offset:24576
    ds_read_b64_tr_b16 a[166:167], v10 offset:25600
    s_waitcnt lgkmcnt(15)
    v_mfma_f32_32x32x16_bf16 v[200:215], a[132:135], v[168:171], v[200:215]
    ds_read_b64_tr_b16 a[168:169], v11 offset:24576
    ds_read_b64_tr_b16 a[170:171], v11 offset:25600
    ds_read_b64_tr_b16 a[172:173], v12 offset:24576
    ds_read_b64_tr_b16 a[174:175], v12 offset:25600
    s_waitcnt lgkmcnt(15)
    v_mfma_f32_32x32x16_bf16 v[216:231], a[136:139], v[168:171], v[216:231]
    ds_read_b64_tr_b16 a[176:177], v9 offset:28672
    ds_read_b64_tr_b16 a[178:179], v9 offset:29696
    ds_read_b64_tr_b16 a[180:181], v10 offset:28672
    ds_read_b64_tr_b16 a[182:183], v10 offset:29696
    v_mfma_f32_32x32x16_bf16 v[232:247], a[140:143], v[168:171], v[232:247]
    ds_read_b64_tr_b16 a[184:185], v11 offset:28672
    ds_read_b64_tr_b16 a[186:187], v11 offset:29696
    ds_read_b64_tr_b16 a[188:189], v12 offset:28672
    ds_read_b64_tr_b16 a[190:191], v12 offset:29696
    s_waitcnt lgkmcnt(15)
    v_mfma_f32_32x32x16_bf16 v[184:199], a[144:147], v[172:175], v[184:199]
    v_mfma_f32_32x32x16_bf16 v[200:215], a[148:151], v[172:175], v[200:215]
    v_mfma_f32_32x32x16_bf16 v[216:231], a[152:155], v[172:175], v[216:231]
    v_mfma_f32_32x32x16_bf16 v[232:247], a[156:159], v[172:175], v[232:247]
    s_waitcnt lgkmcnt(14)
    v_mfma_f32_32x32x16_bf16 v[184:199], a[160:163], v[176:179], v[184:199]
    s_waitcnt lgkmcnt(12)
    v_mfma_f32_32x32x16_bf16 v[200:215], a[164:167], v[176:179], v[200:215]
    s_waitcnt lgkmcnt(10)
    v_mfma_f32_32x32x16_bf16 v[216:231], a[168:171], v[176:179], v[216:231]
    s_waitcnt lgkmcnt(0)
    s_barrier
    v_mfma_f32_32x32x16_bf16 v[232:247], a[172:175], v[176:179], v[232:247]
    v_mfma_f32_32x32x16_bf16 v[184:199], a[176:179], v[180:183], v[184:199]
    v_mfma_f32_32x32x16_bf16 v[200:215], a[180:183], v[180:183], v[200:215]
    v_mfma_f32_32x32x16_bf16 v[216:231], a[184:187], v[180:183], v[216:231]
    v_mfma_f32_32x32x16_bf16 v[232:247], a[188:191], v[180:183], v[232:247]
    v_xor_b32 v249, 0, v17
    v_lshl_add_u32 v9, v249, 6, v16
    v_add_u32 v9, 0x20000, v9
    v_xor_b32 v249, 1, v17
    v_lshl_add_u32 v10, v249, 6, v16
    v_add_u32 v10, 0x20000, v10
    v_xor_b32 v249, 2, v17
    v_lshl_add_u32 v11, v249, 6, v16
    v_add_u32 v11, 0x20000, v11
    v_xor_b32 v249, 3, v17
    v_lshl_add_u32 v12, v249, 6, v16
    v_add_u32 v12, 0x20000, v12
    v_mov_b32 v14, 0xff800000
    v_cvt_pk_bf16_f32 v24, v184, v185
    v_cvt_pk_bf16_f32 v25, v186, v187
    v_cvt_pk_bf16_f32 v26, v188, v189
    v_cvt_pk_bf16_f32 v27, v190, v191
    v_cvt_pk_bf16_f32 v28, v192, v193
    v_cvt_pk_bf16_f32 v29, v194, v195
    v_cvt_pk_bf16_f32 v30, v196, v197
    v_cvt_pk_bf16_f32 v31, v198, v199
    v_cvt_pk_bf16_f32 v32, v200, v201
    v_cvt_pk_bf16_f32 v33, v202, v203
    v_cvt_pk_bf16_f32 v34, v204, v205
    v_cvt_pk_bf16_f32 v35, v206, v207
    v_cvt_pk_bf16_f32 v36, v208, v209
    v_cvt_pk_bf16_f32 v37, v210, v211
    v_cvt_pk_bf16_f32 v38, v212, v213
    v_cvt_pk_bf16_f32 v39, v214, v215
    v_cvt_pk_bf16_f32 v40, v216, v217
    v_cvt_pk_bf16_f32 v41, v218, v219
    v_cvt_pk_bf16_f32 v42, v220, v221
    v_cvt_pk_bf16_f32 v43, v222, v223
    v_cvt_pk_bf16_f32 v44, v224, v225
    v_cvt_pk_bf16_f32 v45, v226, v227
    v_cvt_pk_bf16_f32 v46, v228, v229
    v_cvt_pk_bf16_f32 v47, v230, v231
    v_cvt_pk_bf16_f32 v48, v232, v233
    v_cvt_pk_bf16_f32 v49, v234, v235
    v_cvt_pk_bf16_f32 v50, v236, v237
    v_cvt_pk_bf16_f32 v51, v238, v239
    v_cvt_pk_bf16_f32 v52, v240, v241
    v_cvt_pk_bf16_f32 v53, v242, v243
    v_cvt_pk_bf16_f32 v54, v244, v245
    v_cvt_pk_bf16_f32 v55, v246, v247
    s_mov_b32 s45, s44
    v_mov_b32 v15, 0xff800000
    s_barrier
    ds_read_b128 a[128:131], v1 offset:0
    ds_read_b128 a[132:135], v2 offset:0
    ds_read_b128 a[136:139], v3 offset:0
    ds_read_b128 a[140:143], v4 offset:0
    ds_read_b128 a[144:147], v5 offset:0
    ds_read_b128 a[148:151], v6 offset:0
    ds_read_b128 a[152:155], v7 offset:0
    ds_read_b128 a[156:159], v8 offset:0
    s_waitcnt lgkmcnt(7)
    v_mfma_f32_32x32x16_bf16 v[56:71], a[128:131], v[24:27], 0
    ds_read_b128 a[160:163], v1 offset:8192
    ds_read_b128 a[164:167], v2 offset:8192
    s_waitcnt lgkmcnt(8)
    v_mfma_f32_32x32x16_bf16 v[56:71], a[132:135], v[28:31], v[56:71]
    ds_read_b128 a[168:171], v3 offset:8192
    ds_read_b128 a[172:175], v4 offset:8192
    s_waitcnt lgkmcnt(9)
    v_mfma_f32_32x32x16_bf16 v[56:71], a[136:139], v[32:35], v[56:71]
    ds_read_b128 a[176:179], v5 offset:8192
    ds_read_b128 a[180:183], v6 offset:8192
    s_waitcnt lgkmcnt(10)
    v_mfma_f32_32x32x16_bf16 v[56:71], a[140:143], v[36:39], v[56:71]
    ds_read_b128 a[184:187], v7 offset:8192
    ds_read_b128 a[188:191], v8 offset:8192
    s_waitcnt lgkmcnt(11)
    v_mfma_f32_32x32x16_bf16 v[56:71], a[144:147], v[40:43], v[56:71]
    s_waitcnt lgkmcnt(10)
    v_mfma_f32_32x32x16_bf16 v[56:71], a[148:151], v[44:47], v[56:71]
    s_waitcnt lgkmcnt(9)
    v_mfma_f32_32x32x16_bf16 v[56:71], a[152:155], v[48:51], v[56:71]
    s_waitcnt lgkmcnt(8)
    v_mfma_f32_32x32x16_bf16 v[56:71], a[156:159], v[52:55], v[56:71]
    s_waitcnt lgkmcnt(0)
    s_barrier
    v_mfma_f32_32x32x16_bf16 v[72:87], a[160:163], v[24:27], 0
    ds_read_b128 a[128:131], v1 offset:16384
    ds_read_b128 a[132:135], v2 offset:16384
    v_mfma_f32_32x32x16_bf16 v[72:87], a[164:167], v[28:31], v[72:87]
    ds_read_b128 a[136:139], v3 offset:16384
    ds_read_b128 a[140:143], v4 offset:16384
    v_mfma_f32_32x32x16_bf16 v[72:87], a[168:171], v[32:35], v[72:87]
    ds_read_b128 a[144:147], v5 offset:16384
    ds_read_b128 a[148:151], v6 offset:16384
    s_nop 0
    v_max3_f32 v14, v56, v57, v14
    v_mfma_f32_32x32x16_bf16 v[72:87], a[172:175], v[36:39], v[72:87]
    ds_read_b128 a[152:155], v7 offset:16384
    ds_read_b128 a[156:159], v8 offset:16384
    v_max3_f32 v14, v58, v59, v14
    v_mfma_f32_32x32x16_bf16 v[72:87], a[176:179], v[40:43], v[72:87]
    v_max3_f32 v14, v60, v61, v14
    v_max3_f32 v14, v62, v63, v14
    v_mfma_f32_32x32x16_bf16 v[72:87], a[180:183], v[44:47], v[72:87]
    v_max3_f32 v14, v64, v65, v14
    v_mfma_f32_32x32x16_bf16 v[72:87], a[184:187], v[48:51], v[72:87]
    v_max3_f32 v14, v66, v67, v14
    v_mfma_f32_32x32x16_bf16 v[72:87], a[188:191], v[52:55], v[72:87]
    v_max3_f32 v14, v68, v69, v14
    v_max3_f32 v14, v70, v71, v14
    s_waitcnt lgkmcnt(7)
    v_mfma_f32_32x32x16_bf16 v[88:103], a[128:131], v[24:27], 0
    ds_read_b128 a[160:163], v1 offset:24576
    ds_read_b128 a[164:167], v2 offset:24576
    s_waitcnt lgkmcnt(8)
    v_mfma_f32_32x32x16_bf16 v[88:103], a[132:135], v[28:31], v[88:103]
    ds_read_b128 a[168:171], v3 offset:24576
    ds_read_b128 a[172:175], v4 offset:24576
    s_waitcnt lgkmcnt(9)
    v_mfma_f32_32x32x16_bf16 v[88:103], a[136:139], v[32:35], v[88:103]
    ds_read_b128 a[176:179], v5 offset:24576
    ds_read_b128 a[180:183], v6 offset:24576
    v_max3_f32 v14, v72, v73, v14
    s_waitcnt lgkmcnt(10)
    v_mfma_f32_32x32x16_bf16 v[88:103], a[140:143], v[36:39], v[88:103]
    ds_read_b128 a[184:187], v7 offset:24576
    ds_read_b128 a[188:191], v8 offset:24576
    v_max3_f32 v14, v74, v75, v14
    s_waitcnt lgkmcnt(11)
    v_mfma_f32_32x32x16_bf16 v[88:103], a[144:147], v[40:43], v[88:103]
    v_max3_f32 v14, v76, v77, v14
    v_max3_f32 v14, v78, v79, v14
    s_waitcnt lgkmcnt(10)
    v_mfma_f32_32x32x16_bf16 v[88:103], a[148:151], v[44:47], v[88:103]
    v_max3_f32 v14, v80, v81, v14
    s_waitcnt lgkmcnt(9)
    v_mfma_f32_32x32x16_bf16 v[88:103], a[152:155], v[48:51], v[88:103]
    v_max3_f32 v14, v82, v83, v14
    s_waitcnt lgkmcnt(8)
    v_mfma_f32_32x32x16_bf16 v[88:103], a[156:159], v[52:55], v[88:103]
    v_max3_f32 v14, v84, v85, v14
    v_max3_f32 v14, v86, v87, v14
    s_waitcnt lgkmcnt(7)
    v_mfma_f32_32x32x16_bf16 v[104:119], a[160:163], v[24:27], 0
    ds_read_b128 a[128:131], v1 offset:32768
    ds_read_b128 a[132:135], v2 offset:32768
    s_waitcnt lgkmcnt(8)
    v_mfma_f32_32x32x16_bf16 v[104:119], a[164:167], v[28:31], v[104:119]
    ds_read_b128 a[136:139], v3 offset:32768
    ds_read_b128 a[140:143], v4 offset:32768
    s_waitcnt lgkmcnt(9)
    v_mfma_f32_32x32x16_bf16 v[104:119], a[168:171], v[32:35], v[104:119]
    ds_read_b128 a[144:147], v5 offset:32768
    ds_read_b128 a[148:151], v6 offset:32768
    v_max3_f32 v14, v88, v89, v14
    s_waitcnt lgkmcnt(10)
    v_mfma_f32_32x32x16_bf16 v[104:119], a[172:175], v[36:39], v[104:119]
    ds_read_b128 a[152:155], v7 offset:32768
    ds_read_b128 a[156:159], v8 offset:32768
    v_max3_f32 v14, v90, v91, v14
    s_waitcnt lgkmcnt(11)
    v_mfma_f32_32x32x16_bf16 v[104:119], a[176:179], v[40:43], v[104:119]
    v_max3_f32 v14, v92, v93, v14
    v_max3_f32 v14, v94, v95, v14
    s_waitcnt lgkmcnt(10)
    v_mfma_f32_32x32x16_bf16 v[104:119], a[180:183], v[44:47], v[104:119]
    v_max3_f32 v14, v96, v97, v14
    s_waitcnt lgkmcnt(9)
    v_mfma_f32_32x32x16_bf16 v[104:119], a[184:187], v[48:51], v[104:119]
    v_max3_f32 v14, v98, v99, v14
    s_waitcnt lgkmcnt(8)
    v_mfma_f32_32x32x16_bf16 v[104:119], a[188:191], v[52:55], v[104:119]
    v_max3_f32 v14, v100, v101, v14
    v_max3_f32 v14, v102, v103, v14
    s_waitcnt lgkmcnt(7)
    v_mfma_f32_32x32x16_bf16 v[120:135], a[128:131], v[24:27], 0
    ds_read_b128 a[160:163], v1 offset:40960
    ds_read_b128 a[164:167], v2 offset:40960
    s_waitcnt lgkmcnt(8)
    v_mfma_f32_32x32x16_bf16 v[120:135], a[132:135], v[28:31], v[120:135]
    ds_read_b128 a[168:171], v3 offset:40960
    ds_read_b128 a[172:175], v4 offset:40960
    s_waitcnt lgkmcnt(9)
    v_mfma_f32_32x32x16_bf16 v[120:135], a[136:139], v[32:35], v[120:135]
    ds_read_b128 a[176:179], v5 offset:40960
    ds_read_b128 a[180:183], v6 offset:40960
    v_max3_f32 v14, v104, v105, v14
    s_waitcnt lgkmcnt(10)
    v_mfma_f32_32x32x16_bf16 v[120:135], a[140:143], v[36:39], v[120:135]
    ds_read_b128 a[184:187], v7 offset:40960
    ds_read_b128 a[188:191], v8 offset:40960
    v_max3_f32 v14, v106, v107, v14
    s_waitcnt lgkmcnt(11)
    v_mfma_f32_32x32x16_bf16 v[120:135], a[144:147], v[40:43], v[120:135]
    v_max3_f32 v14, v108, v109, v14
    v_max3_f32 v14, v110, v111, v14
    s_waitcnt lgkmcnt(10)
    v_mfma_f32_32x32x16_bf16 v[120:135], a[148:151], v[44:47], v[120:135]
    v_max3_f32 v14, v112, v113, v14
    s_waitcnt lgkmcnt(9)
    v_mfma_f32_32x32x16_bf16 v[120:135], a[152:155], v[48:51], v[120:135]
    v_max3_f32 v14, v114, v115, v14
    s_waitcnt lgkmcnt(8)
    v_mfma_f32_32x32x16_bf16 v[120:135], a[156:159], v[52:55], v[120:135]
    v_max3_f32 v14, v116, v117, v14
    v_max3_f32 v14, v118, v119, v14
    s_waitcnt lgkmcnt(0)
    s_barrier
    v_mfma_f32_32x32x16_bf16 v[136:151], a[160:163], v[24:27], 0
    ds_read_b128 a[128:131], v1 offset:49152
    ds_read_b128 a[132:135], v2 offset:49152
    v_mfma_f32_32x32x16_bf16 v[136:151], a[164:167], v[28:31], v[136:151]
    ds_read_b128 a[136:139], v3 offset:49152
    ds_read_b128 a[140:143], v4 offset:49152
    v_mfma_f32_32x32x16_bf16 v[136:151], a[168:171], v[32:35], v[136:151]
    ds_read_b128 a[144:147], v5 offset:49152
    ds_read_b128 a[148:151], v6 offset:49152
    v_max3_f32 v14, v120, v121, v14
    v_mfma_f32_32x32x16_bf16 v[136:151], a[172:175], v[36:39], v[136:151]
    ds_read_b128 a[152:155], v7 offset:49152
    ds_read_b128 a[156:159], v8 offset:49152
    v_max3_f32 v14, v122, v123, v14
    v_mfma_f32_32x32x16_bf16 v[136:151], a[176:179], v[40:43], v[136:151]
    v_max3_f32 v14, v124, v125, v14
    v_max3_f32 v14, v126, v127, v14
    v_mfma_f32_32x32x16_bf16 v[136:151], a[180:183], v[44:47], v[136:151]
    v_max3_f32 v14, v128, v129, v14
    v_mfma_f32_32x32x16_bf16 v[136:151], a[184:187], v[48:51], v[136:151]
    v_max3_f32 v14, v130, v131, v14
    v_mfma_f32_32x32x16_bf16 v[136:151], a[188:191], v[52:55], v[136:151]
    v_max3_f32 v14, v132, v133, v14
    v_max3_f32 v14, v134, v135, v14
    s_waitcnt lgkmcnt(7)
    v_mfma_f32_32x32x16_bf16 v[152:167], a[128:131], v[24:27], 0
    ds_read_b128 a[160:163], v1 offset:57344
    ds_read_b128 a[164:167], v2 offset:57344
    s_waitcnt lgkmcnt(8)
    v_mfma_f32_32x32x16_bf16 v[152:167], a[132:135], v[28:31], v[152:167]
    ds_read_b128 a[168:171], v3 offset:57344
    ds_read_b128 a[172:175], v4 offset:57344
    s_waitcnt lgkmcnt(9)
    v_mfma_f32_32x32x16_bf16 v[152:167], a[136:139], v[32:35], v[152:167]
    ds_read_b128 a[176:179], v5 offset:57344
    ds_read_b128 a[180:183], v6 offset:57344
    v_max3_f32 v14, v136, v137, v14
    s_waitcnt lgkmcnt(10)
    v_mfma_f32_32x32x16_bf16 v[152:167], a[140:143], v[36:39], v[152:167]
    ds_read_b128 a[184:187], v7 offset:57344
    ds_read_b128 a[188:191], v8 offset:57344
    v_max3_f32 v14, v138, v139, v14
    s_waitcnt lgkmcnt(11)
    v_mfma_f32_32x32x16_bf16 v[152:167], a[144:147], v[40:43], v[152:167]
    v_max3_f32 v14, v140, v141, v14
    v_max3_f32 v14, v142, v143, v14
    s_waitcnt lgkmcnt(10)
    v_mfma_f32_32x32x16_bf16 v[152:167], a[148:151], v[44:47], v[152:167]
    v_max3_f32 v14, v144, v145, v14
    s_waitcnt lgkmcnt(9)
    v_mfma_f32_32x32x16_bf16 v[152:167], a[152:155], v[48:51], v[152:167]
    v_max3_f32 v14, v146, v147, v14
    s_waitcnt lgkmcnt(8)
    v_mfma_f32_32x32x16_bf16 v[152:167], a[156:159], v[52:55], v[152:167]
    v_max3_f32 v14, v148, v149, v14
    v_max3_f32 v14, v150, v151, v14
    v_add_u32 v1, 0x10000, v1
    v_add_u32 v2, 0x10000, v2
    v_add_u32 v3, 0x10000, v3
    v_add_u32 v4, 0x10000, v4
    v_add_u32 v5, 0x10000, v5
    v_add_u32 v6, 0x10000, v6
    v_add_u32 v7, 0x10000, v7
    v_add_u32 v8, 0x10000, v8
    s_waitcnt lgkmcnt(7)
    v_mfma_f32_32x32x16_bf16 v[168:183], a[160:163], v[24:27], 0
    ds_read_b128 a[128:131], v1 offset:0
    ds_read_b128 a[132:135], v2 offset:0
    s_waitcnt lgkmcnt(8)
    v_mfma_f32_32x32x16_bf16 v[168:183], a[164:167], v[28:31], v[168:183]
    ds_read_b128 a[136:139], v3 offset:0
    ds_read_b128 a[140:143], v4 offset:0
    s_waitcnt lgkmcnt(9)
    v_mfma_f32_32x32x16_bf16 v[168:183], a[168:171], v[32:35], v[168:183]
    ds_read_b128 a[144:147], v5 offset:0
    ds_read_b128 a[148:151], v6 offset:0
    v_max3_f32 v14, v152, v153, v14
    s_waitcnt lgkmcnt(10)
    v_mfma_f32_32x32x16_bf16 v[168:183], a[172:175], v[36:39], v[168:183]
    ds_read_b128 a[152:155], v7 offset:0
    ds_read_b128 a[156:159], v8 offset:0
    v_max3_f32 v14, v154, v155, v14
    s_waitcnt lgkmcnt(11)
    v_mfma_f32_32x32x16_bf16 v[168:183], a[176:179], v[40:43], v[168:183]
    v_max3_f32 v14, v156, v157, v14
    v_max3_f32 v14, v158, v159, v14
    s_waitcnt lgkmcnt(10)
    v_mfma_f32_32x32x16_bf16 v[168:183], a[180:183], v[44:47], v[168:183]
    v_max3_f32 v14, v160, v161, v14
    s_waitcnt lgkmcnt(9)
    v_mfma_f32_32x32x16_bf16 v[168:183], a[184:187], v[48:51], v[168:183]
    v_max3_f32 v14, v162, v163, v14
    s_waitcnt lgkmcnt(8)
    v_mfma_f32_32x32x16_bf16 v[168:183], a[188:191], v[52:55], v[168:183]
    v_max3_f32 v14, v164, v165, v14
    v_max3_f32 v14, v166, v167, v14
    s_waitcnt lgkmcnt(7)
    v_mfma_f32_32x32x16_bf16 v[184:199], a[128:131], v[24:27], 0
    ds_read_b128 a[160:163], v1 offset:8192
    ds_read_b128 a[164:167], v2 offset:8192
    s_waitcnt lgkmcnt(8)
    v_mfma_f32_32x32x16_bf16 v[184:199], a[132:135], v[28:31], v[184:199]
    ds_read_b128 a[168:171], v3 offset:8192
    ds_read_b128 a[172:175], v4 offset:8192
    s_waitcnt lgkmcnt(9)
    v_mfma_f32_32x32x16_bf16 v[184:199], a[136:139], v[32:35], v[184:199]
    ds_read_b128 a[176:179], v5 offset:8192
    ds_read_b128 a[180:183], v6 offset:8192
    v_max3_f32 v14, v168, v169, v14
    v_max3_f32 v14, v170, v171, v14
    s_waitcnt lgkmcnt(10)
    v_mfma_f32_32x32x16_bf16 v[184:199], a[140:143], v[36:39], v[184:199]
    ds_read_b128 a[184:187], v7 offset:8192
    ds_read_b128 a[188:191], v8 offset:8192
    v_max3_f32 v14, v172, v173, v14
    v_max3_f32 v14, v174, v175, v14
    v_max3_f32 v14, v176, v177, v14
    s_waitcnt lgkmcnt(11)
    v_mfma_f32_32x32x16_bf16 v[184:199], a[144:147], v[40:43], v[184:199]
    v_max3_f32 v14, v178, v179, v14
    v_max3_f32 v14, v180, v181, v14
    v_max3_f32 v14, v182, v183, v14
    s_waitcnt lgkmcnt(10)
    v_mfma_f32_32x32x16_bf16 v[184:199], a[148:151], v[44:47], v[184:199]
    v_mov_b32 v18, v14
    v_mov_b32 v19, v14
    s_waitcnt lgkmcnt(9)
    v_mfma_f32_32x32x16_bf16 v[184:199], a[152:155], v[48:51], v[184:199]
    v_permlane32_swap_b32 v18, v19
    v_max_f32 v14, v18, v19
    v_mul_f32 v248, s44, v14
    s_waitcnt lgkmcnt(8)
    v_mfma_f32_32x32x16_bf16 v[184:199], a[156:159], v[52:55], v[184:199]
    v_mul_f32 v249, s44, v14
    v_mov_b32 v250, 0
    v_mov_b32 v251, 0
    s_waitcnt lgkmcnt(0)
    s_barrier
    v_mfma_f32_32x32x16_bf16 v[200:215], a[160:163], v[24:27], 0
    ds_read_b128 a[128:131], v1 offset:16384
    ds_read_b128 a[132:135], v2 offset:16384
    v_mfma_f32_32x32x16_bf16 v[200:215], a[164:167], v[28:31], v[200:215]
    ds_read_b128 a[136:139], v3 offset:16384
    ds_read_b128 a[140:143], v4 offset:16384
    v_mfma_f32_32x32x16_bf16 v[200:215], a[168:171], v[32:35], v[200:215]
    ds_read_b128 a[144:147], v5 offset:16384
    ds_read_b128 a[148:151], v6 offset:16384
    v_max3_f32 v15, v184, v185, v15
    v_max3_f32 v15, v186, v187, v15
    v_max3_f32 v15, v188, v189, v15
    v_max3_f32 v15, v190, v191, v15
    v_max3_f32 v15, v192, v193, v15
    v_max3_f32 v15, v194, v195, v15
    v_max3_f32 v15, v196, v197, v15
    v_max3_f32 v15, v198, v199, v15
    v_fma_f32 v56, v56, s44, -v248
    v_fma_f32 v57, v57, s44, -v248
    v_mfma_f32_32x32x16_bf16 v[200:215], a[172:175], v[36:39], v[200:215]
    ds_read_b128 a[152:155], v7 offset:16384
    ds_read_b128 a[156:159], v8 offset:16384
    v_fma_f32 v58, v58, s44, -v248
    v_fma_f32 v59, v59, s44, -v248
    v_exp_f32 v56, v56
    v_exp_f32 v57, v57
    v_fma_f32 v60, v60, s44, -v248
    v_fma_f32 v61, v61, s44, -v248
    v_exp_f32 v58, v58
    v_exp_f32 v59, v59
    v_add_f32 v250, v250, v56
    v_add_f32 v251, v251, v57
    v_fma_f32 v62, v62, s44, -v248
    v_mfma_f32_32x32x16_bf16 v[200:215], a[176:179], v[40:43], v[200:215]
    v_fma_f32 v63, v63, s44, -v248
    v_exp_f32 v60, v60
    v_exp_f32 v61, v61
    v_add_f32 v250, v250, v58
    v_add_f32 v251, v251, v59
    v_cvt_pk_bf16_f32 v56, v56, v57
    v_fma_f32 v64, v64, s44, -v248
    v_fma_f32 v65, v65, s44, -v248
    v_exp_f32 v62, v62
    v_exp_f32 v63, v63
    v_add_f32 v250, v250, v60
    v_mfma_f32_32x32x16_bf16 v[200:215], a[180:183], v[44:47], v[200:215]
    v_add_f32 v251, v251, v61
    v_cvt_pk_bf16_f32 v57, v58, v59
    v_fma_f32 v66, v66, s44, -v248
    v_fma_f32 v67, v67, s44, -v248
    v_exp_f32 v64, v64
    v_exp_f32 v65, v65
    v_add_f32 v250, v250, v62
    v_add_f32 v251, v251, v63
    v_cvt_pk_bf16_f32 v58, v60, v61
    v_fma_f32 v68, v68, s44, -v248
    v_mfma_f32_32x32x16_bf16 v[200:215], a[184:187], v[48:51], v[200:215]
    v_fma_f32 v69, v69, s44, -v248
    v_exp_f32 v66, v66
    v_exp_f32 v67, v67
    v_add_f32 v250, v250, v64
    v_add_f32 v251, v251, v65
    v_cvt_pk_bf16_f32 v59, v62, v63
    v_fma_f32 v70, v70, s44, -v248
    v_fma_f32 v71, v71, s44, -v248
    v_exp_f32 v68, v68
    v_exp_f32 v69, v69
    v_add_f32 v250, v250, v66
    v_mfma_f32_32x32x16_bf16 v[200:215], a[188:191], v[52:55], v[200:215]
    v_add_f32 v251, v251, v67
    v_cvt_pk_bf16_f32 v60, v64, v65
    v_exp_f32 v70, v70
    v_exp_f32 v71, v71
    v_add_f32 v250, v250, v68
    v_add_f32 v251, v251, v69
    v_cvt_pk_bf16_f32 v61, v66, v67
    v_add_f32 v250, v250, v70
    v_add_f32 v251, v251, v71
    v_cvt_pk_bf16_f32 v62, v68, v69
    v_cvt_pk_bf16_f32 v63, v70, v71
    s_waitcnt lgkmcnt(7)
    v_mfma_f32_32x32x16_bf16 v[216:231], a[128:131], v[24:27], 0
    ds_read_b128 a[160:163], v1 offset:24576
    ds_read_b128 a[164:167], v2 offset:24576
    s_waitcnt lgkmcnt(8)
    v_mfma_f32_32x32x16_bf16 v[216:231], a[132:135], v[28:31], v[216:231]
    ds_read_b128 a[168:171], v3 offset:24576
    ds_read_b128 a[172:175], v4 offset:24576
    s_waitcnt lgkmcnt(9)
    v_mfma_f32_32x32x16_bf16 v[216:231], a[136:139], v[32:35], v[216:231]
    ds_read_b128 a[176:179], v5 offset:24576
    ds_read_b128 a[180:183], v6 offset:24576
    v_max3_f32 v15, v200, v201, v15
    v_max3_f32 v15, v202, v203, v15
    v_max3_f32 v15, v204, v205, v15
    v_max3_f32 v15, v206, v207, v15
    v_max3_f32 v15, v208, v209, v15
    v_max3_f32 v15, v210, v211, v15
    v_max3_f32 v15, v212, v213, v15
    v_max3_f32 v15, v214, v215, v15
    v_fma_f32 v72, v72, s44, -v248
    v_fma_f32 v73, v73, s44, -v248
    s_waitcnt lgkmcnt(10)
    v_mfma_f32_32x32x16_bf16 v[216:231], a[140:143], v[36:39], v[216:231]
    ds_read_b128 a[184:187], v7 offset:24576
    ds_read_b128 a[188:191], v8 offset:24576
    v_fma_f32 v74, v74, s44, -v248
    v_fma_f32 v75, v75, s44, -v248
    v_exp_f32 v72, v72
    v_exp_f32 v73, v73
    v_fma_f32 v76, v76, s44, -v248
    v_fma_f32 v77, v77, s44, -v248
    v_exp_f32 v74, v74
    v_exp_f32 v75, v75
    v_add_f32 v250, v250, v72
    v_add_f32 v251, v251, v73
    v_fma_f32 v78, v78, s44, -v248
    s_waitcnt lgkmcnt(11)
    v_mfma_f32_32x32x16_bf16 v[216:231], a[144:147], v[40:43], v[216:231]
    v_fma_f32 v79, v79, s44, -v248
    v_exp_f32 v76, v76
    v_exp_f32 v77, v77
    v_add_f32 v250, v250, v74
    v_add_f32 v251, v251, v75
    v_cvt_pk_bf16_f32 v72, v72, v73
    v_fma_f32 v80, v80, s44, -v248
    v_fma_f32 v81, v81, s44, -v248
    v_exp_f32 v78, v78
    v_exp_f32 v79, v79
    v_add_f32 v250, v250, v76
    s_waitcnt lgkmcnt(10)
    v_mfma_f32_32x32x16_bf16 v[216:231], a[148:151], v[44:47], v[216:231]
    v_add_f32 v251, v251, v77
    v_cvt_pk_bf16_f32 v73, v74, v75
    v_fma_f32 v82, v82, s44, -v248
    v_fma_f32 v83, v83, s44, -v248
    v_exp_f32 v80, v80
    v_exp_f32 v81, v81
    v_add_f32 v250, v250, v78
    v_add_f32 v251, v251, v79
    v_cvt_pk_bf16_f32 v74, v76, v77
    v_fma_f32 v84, v84, s44, -v248
    s_waitcnt lgkmcnt(9)
    v_mfma_f32_32x32x16_bf16 v[216:231], a[152:155], v[48:51], v[216:231]
    v_fma_f32 v85, v85, s44, -v248
    v_exp_f32 v82, v82
    v_exp_f32 v83, v83
    v_add_f32 v250, v250, v80
    v_add_f32 v251, v251, v81
    v_cvt_pk_bf16_f32 v75, v78, v79
    v_fma_f32 v86, v86, s44, -v248
    v_fma_f32 v87, v87, s44, -v248
    v_exp_f32 v84, v84
    v_exp_f32 v85, v85
    v_add_f32 v250, v250, v82
    s_waitcnt lgkmcnt(8)
    v_mfma_f32_32x32x16_bf16 v[216:231], a[156:159], v[52:55], v[216:231]
    v_add_f32 v251, v251, v83
    v_cvt_pk_bf16_f32 v76, v80, v81
    v_exp_f32 v86, v86
    v_exp_f32 v87, v87
    v_add_f32 v250, v250, v84
    v_add_f32 v251, v251, v85
    v_cvt_pk_bf16_f32 v77, v82, v83
    v_add_f32 v250, v250, v86
    v_add_f32 v251, v251, v87
    v_cvt_pk_bf16_f32 v78, v84, v85
    v_cvt_pk_bf16_f32 v79, v86, v87
    s_waitcnt lgkmcnt(7)
    v_mfma_f32_32x32x16_bf16 v[232:247], a[160:163], v[24:27], 0
    ds_read_b128 a[128:131], v1 offset:32768
    ds_read_b128 a[132:135], v2 offset:32768
    s_waitcnt lgkmcnt(8)
    v_mfma_f32_32x32x16_bf16 v[232:247], a[164:167], v[28:31], v[232:247]
    ds_read_b128 a[136:139], v3 offset:32768
    ds_read_b128 a[140:143], v4 offset:32768
    s_waitcnt lgkmcnt(9)
    v_mfma_f32_32x32x16_bf16 v[232:247], a[168:171], v[32:35], v[232:247]
    ds_read_b128 a[144:147], v5 offset:32768
    ds_read_b128 a[148:151], v6 offset:32768
    v_max3_f32 v15, v216, v217, v15
    v_max3_f32 v15, v218, v219, v15
    v_max3_f32 v15, v220, v221, v15
    v_max3_f32 v15, v222, v223, v15
    v_max3_f32 v15, v224, v225, v15
    v_max3_f32 v15, v226, v227, v15
    v_max3_f32 v15, v228, v229, v15
    v_max3_f32 v15, v230, v231, v15
    v_fma_f32 v88, v88, s44, -v248
    v_fma_f32 v89, v89, s44, -v248
    s_waitcnt lgkmcnt(10)
    v_mfma_f32_32x32x16_bf16 v[232:247], a[172:175], v[36:39], v[232:247]
    ds_read_b128 a[152:155], v7 offset:32768
    ds_read_b128 a[156:159], v8 offset:32768
    v_fma_f32 v90, v90, s44, -v248
    v_fma_f32 v91, v91, s44, -v248
    v_exp_f32 v88, v88
    v_exp_f32 v89, v89
    v_fma_f32 v92, v92, s44, -v248
    v_fma_f32 v93, v93, s44, -v248
    v_exp_f32 v90, v90
    v_exp_f32 v91, v91
    v_add_f32 v250, v250, v88
    v_add_f32 v251, v251, v89
    v_fma_f32 v94, v94, s44, -v248
    s_waitcnt lgkmcnt(11)
    v_mfma_f32_32x32x16_bf16 v[232:247], a[176:179], v[40:43], v[232:247]
    v_fma_f32 v95, v95, s44, -v248
    v_exp_f32 v92, v92
    v_exp_f32 v93, v93
    v_add_f32 v250, v250, v90
    v_add_f32 v251, v251, v91
    v_cvt_pk_bf16_f32 v88, v88, v89
    v_fma_f32 v96, v96, s44, -v248
    v_fma_f32 v97, v97, s44, -v248
    v_exp_f32 v94, v94
    v_exp_f32 v95, v95
    v_add_f32 v250, v250, v92
    s_waitcnt lgkmcnt(10)
    v_mfma_f32_32x32x16_bf16 v[232:247], a[180:183], v[44:47], v[232:247]
    v_add_f32 v251, v251, v93
    v_cvt_pk_bf16_f32 v89, v90, v91
    v_fma_f32 v98, v98, s44, -v248
    v_fma_f32 v99, v99, s44, -v248
    v_exp_f32 v96, v96
    v_exp_f32 v97, v97
    v_add_f32 v250, v250, v94
    v_add_f32 v251, v251, v95
    v_cvt_pk_bf16_f32 v90, v92, v93
    v_fma_f32 v100, v100, s44, -v248
    s_waitcnt lgkmcnt(9)
    v_mfma_f32_32x32x16_bf16 v[232:247], a[184:187], v[48:51], v[232:247]
    v_fma_f32 v101, v101, s44, -v248
    v_exp_f32 v98, v98
    v_exp_f32 v99, v99
    v_add_f32 v250, v250, v96
    v_add_f32 v251, v251, v97
    v_cvt_pk_bf16_f32 v91, v94, v95
    v_fma_f32 v102, v102, s44, -v248
    v_fma_f32 v103, v103, s44, -v248
    v_exp_f32 v100, v100
    v_exp_f32 v101, v101
    v_add_f32 v250, v250, v98
    s_waitcnt lgkmcnt(8)
    v_mfma_f32_32x32x16_bf16 v[232:247], a[188:191], v[52:55], v[232:247]
    v_add_f32 v251, v251, v99
    v_cvt_pk_bf16_f32 v92, v96, v97
    v_exp_f32 v102, v102
    v_exp_f32 v103, v103
    v_add_f32 v250, v250, v100
    v_add_f32 v251, v251, v101
    v_cvt_pk_bf16_f32 v93, v98, v99
    v_add_f32 v250, v250, v102
    v_add_f32 v251, v251, v103
    v_cvt_pk_bf16_f32 v94, v100, v101
    v_cvt_pk_bf16_f32 v95, v102, v103
    s_waitcnt lgkmcnt(7)
    v_mfma_f32_32x32x16_bf16 a[0:15], a[128:131], v[24:27], 0
    ds_read_b128 a[160:163], v1 offset:40960
    ds_read_b128 a[164:167], v2 offset:40960
    s_waitcnt lgkmcnt(8)
    v_mfma_f32_32x32x16_bf16 a[0:15], a[132:135], v[28:31], a[0:15]
    ds_read_b128 a[168:171], v3 offset:40960
    ds_read_b128 a[172:175], v4 offset:40960
    s_waitcnt lgkmcnt(9)
    v_mfma_f32_32x32x16_bf16 a[0:15], a[136:139], v[32:35], a[0:15]
    ds_read_b128 a[176:179], v5 offset:40960
    ds_read_b128 a[180:183], v6 offset:40960
    v_max3_f32 v15, v232, v233, v15
    v_max3_f32 v15, v234, v235, v15
    v_max3_f32 v15, v236, v237, v15
    v_max3_f32 v15, v238, v239, v15
    v_max3_f32 v15, v240, v241, v15
    v_max3_f32 v15, v242, v243, v15
    v_max3_f32 v15, v244, v245, v15
    v_max3_f32 v15, v246, v247, v15
    v_fma_f32 v104, v104, s44, -v248
    v_fma_f32 v105, v105, s44, -v248
    s_waitcnt lgkmcnt(10)
    v_mfma_f32_32x32x16_bf16 a[0:15], a[140:143], v[36:39], a[0:15]
    ds_read_b128 a[184:187], v7 offset:40960
    ds_read_b128 a[188:191], v8 offset:40960
    v_fma_f32 v106, v106, s44, -v248
    v_fma_f32 v107, v107, s44, -v248
    v_exp_f32 v104, v104
    v_exp_f32 v105, v105
    v_fma_f32 v108, v108, s44, -v248
    v_fma_f32 v109, v109, s44, -v248
    v_exp_f32 v106, v106
    v_exp_f32 v107, v107
    v_add_f32 v250, v250, v104
    v_add_f32 v251, v251, v105
    v_fma_f32 v110, v110, s44, -v248
    s_waitcnt lgkmcnt(11)
    v_mfma_f32_32x32x16_bf16 a[0:15], a[144:147], v[40:43], a[0:15]
    v_fma_f32 v111, v111, s44, -v248
    v_exp_f32 v108, v108
    v_exp_f32 v109, v109
    v_add_f32 v250, v250, v106
    v_add_f32 v251, v251, v107
    v_cvt_pk_bf16_f32 v104, v104, v105
    v_fma_f32 v112, v112, s44, -v248
    v_fma_f32 v113, v113, s44, -v248
    v_exp_f32 v110, v110
    v_exp_f32 v111, v111
    v_add_f32 v250, v250, v108
    s_waitcnt lgkmcnt(10)
    v_mfma_f32_32x32x16_bf16 a[0:15], a[148:151], v[44:47], a[0:15]
    v_add_f32 v251, v251, v109
    v_cvt_pk_bf16_f32 v105, v106, v107
    v_fma_f32 v114, v114, s44, -v248
    v_fma_f32 v115, v115, s44, -v248
    v_exp_f32 v112, v112
    v_exp_f32 v113, v113
    v_add_f32 v250, v250, v110
    v_add_f32 v251, v251, v111
    v_cvt_pk_bf16_f32 v106, v108, v109
    v_fma_f32 v116, v116, s44, -v248
    s_waitcnt lgkmcnt(9)
    v_mfma_f32_32x32x16_bf16 a[0:15], a[152:155], v[48:51], a[0:15]
    v_fma_f32 v117, v117, s44, -v248
    v_exp_f32 v114, v114
    v_exp_f32 v115, v115
    v_add_f32 v250, v250, v112
    v_add_f32 v251, v251, v113
    v_cvt_pk_bf16_f32 v107, v110, v111
    v_fma_f32 v118, v118, s44, -v248
    v_fma_f32 v119, v119, s44, -v248
    v_exp_f32 v116, v116
    v_exp_f32 v117, v117
    v_add_f32 v250, v250, v114
    s_waitcnt lgkmcnt(8)
    v_mfma_f32_32x32x16_bf16 a[0:15], a[156:159], v[52:55], a[0:15]
    v_add_f32 v251, v251, v115
    v_cvt_pk_bf16_f32 v108, v112, v113
    v_exp_f32 v118, v118
    v_exp_f32 v119, v119
    v_add_f32 v250, v250, v116
    v_add_f32 v251, v251, v117
    v_cvt_pk_bf16_f32 v109, v114, v115
    v_add_f32 v250, v250, v118
    v_add_f32 v251, v251, v119
    v_cvt_pk_bf16_f32 v110, v116, v117
    v_cvt_pk_bf16_f32 v111, v118, v119
    s_waitcnt lgkmcnt(0)
    s_barrier
    v_mfma_f32_32x32x16_bf16 a[16:31], a[160:163], v[24:27], 0
    ds_read_b128 a[128:131], v1 offset:49152
    ds_read_b128 a[132:135], v2 offset:49152
    v_mfma_f32_32x32x16_bf16 a[16:31], a[164:167], v[28:31], a[16:31]
    ds_read_b128 a[136:139], v3 offset:49152
    ds_read_b128 a[140:143], v4 offset:49152
    v_mfma_f32_32x32x16_bf16 a[16:31], a[168:171], v[32:35], a[16:31]
    ds_read_b128 a[144:147], v5 offset:49152
    ds_read_b128 a[148:151], v6 offset:49152
    v_accvgpr_read_b32 v252, a0
    v_accvgpr_read_b32 v253, a1
    v_max3_f32 v15, v252, v253, v15
    v_accvgpr_read_b32 v254, a2
    v_accvgpr_read_b32 v255, a3
    v_max3_f32 v15, v254, v255, v15
    v_accvgpr_read_b32 v252, a4
    v_accvgpr_read_b32 v253, a5
    v_max3_f32 v15, v252, v253, v15
    v_accvgpr_read_b32 v254, a6
    v_accvgpr_read_b32 v255, a7
    v_max3_f32 v15, v254, v255, v15
    v_accvgpr_read_b32 v252, a8
    v_mfma_f32_32x32x16_bf16 a[16:31], a[172:175], v[36:39], a[16:31]
    ds_read_b128 a[152:155], v7 offset:49152
    ds_read_b128 a[156:159], v8 offset:49152
    v_accvgpr_read_b32 v253, a9
    v_max3_f32 v15, v252, v253, v15
    v_accvgpr_read_b32 v254, a10
    v_accvgpr_read_b32 v255, a11
    v_max3_f32 v15, v254, v255, v15
    v_accvgpr_read_b32 v252, a12
    v_accvgpr_read_b32 v253, a13
    v_max3_f32 v15, v252, v253, v15
    v_accvgpr_read_b32 v254, a14
    v_accvgpr_read_b32 v255, a15
    v_max3_f32 v15, v254, v255, v15
    v_fma_f32 v120, v120, s44, -v248
    v_fma_f32 v121, v121, s44, -v248
    v_mfma_f32_32x32x16_bf16 a[16:31], a[176:179], v[40:43], a[16:31]
    v_fma_f32 v122, v122, s44, -v248
    v_fma_f32 v123, v123, s44, -v248
    v_exp_f32 v120, v120
    v_exp_f32 v121, v121
    v_fma_f32 v124, v124, s44, -v248
    v_fma_f32 v125, v125, s44, -v248
    v_exp_f32 v122, v122
    v_exp_f32 v123, v123
    v_add_f32 v250, v250, v120
    v_add_f32 v251, v251, v121
    v_fma_f32 v126, v126, s44, -v248
    v_fma_f32 v127, v127, s44, -v248
    v_exp_f32 v124, v124
    v_exp_f32 v125, v125
    v_mfma_f32_32x32x16_bf16 a[16:31], a[180:183], v[44:47], a[16:31]
    v_add_f32 v250, v250, v122
    v_add_f32 v251, v251, v123
    v_cvt_pk_bf16_f32 v120, v120, v121
    v_fma_f32 v128, v128, s44, -v248
    v_fma_f32 v129, v129, s44, -v248
    v_exp_f32 v126, v126
    v_exp_f32 v127, v127
    v_add_f32 v250, v250, v124
    v_add_f32 v251, v251, v125
    v_cvt_pk_bf16_f32 v121, v122, v123
    v_fma_f32 v130, v130, s44, -v248
    v_fma_f32 v131, v131, s44, -v248
    v_exp_f32 v128, v128
    v_mfma_f32_32x32x16_bf16 a[16:31], a[184:187], v[48:51], a[16:31]
    v_exp_f32 v129, v129
    v_add_f32 v250, v250, v126
    v_add_f32 v251, v251, v127
    v_cvt_pk_bf16_f32 v122, v124, v125
    v_fma_f32 v132, v132, s44, -v248
    v_fma_f32 v133, v133, s44, -v248
    v_exp_f32 v130, v130
    v_exp_f32 v131, v131
    v_add_f32 v250, v250, v128
    v_add_f32 v251, v251, v129
    v_cvt_pk_bf16_f32 v123, v126, v127
    v_fma_f32 v134, v134, s44, -v248
    v_fma_f32 v135, v135, s44, -v248
    v_mfma_f32_32x32x16_bf16 a[16:31], a[188:191], v[52:55], a[16:31]
    v_exp_f32 v132, v132
    v_exp_f32 v133, v133
    v_add_f32 v250, v250, v130
    v_add_f32 v251, v251, v131
    v_cvt_pk_bf16_f32 v124, v128, v129
    v_exp_f32 v134, v134
    v_exp_f32 v135, v135
    v_add_f32 v250, v250, v132
    v_add_f32 v251, v251, v133
    v_cvt_pk_bf16_f32 v125, v130, v131
    v_add_f32 v250, v250, v134
    v_add_f32 v251, v251, v135
    v_cvt_pk_bf16_f32 v126, v132, v133
    v_cvt_pk_bf16_f32 v127, v134, v135
    s_waitcnt lgkmcnt(7)
    v_mfma_f32_32x32x16_bf16 a[32:47], a[128:131], v[24:27], 0
    ds_read_b128 a[160:163], v1 offset:57344
    ds_read_b128 a[164:167], v2 offset:57344
    s_waitcnt lgkmcnt(8)
    v_mfma_f32_32x32x16_bf16 a[32:47], a[132:135], v[28:31], a[32:47]
    ds_read_b128 a[168:171], v3 offset:57344
    ds_read_b128 a[172:175], v4 offset:57344
    s_waitcnt lgkmcnt(9)
    v_mfma_f32_32x32x16_bf16 a[32:47], a[136:139], v[32:35], a[32:47]
    ds_read_b128 a[176:179], v5 offset:57344
    ds_read_b128 a[180:183], v6 offset:57344
    v_accvgpr_read_b32 v252, a16
    v_accvgpr_read_b32 v253, a17
    v_max3_f32 v15, v252, v253, v15
    v_accvgpr_read_b32 v254, a18
    v_accvgpr_read_b32 v255, a19
    v_max3_f32 v15, v254, v255, v15
    v_accvgpr_read_b32 v252, a20
    v_accvgpr_read_b32 v253, a21
    v_max3_f32 v15, v252, v253, v15
    v_accvgpr_read_b32 v254, a22
    v_accvgpr_read_b32 v255, a23
    v_max3_f32 v15, v254, v255, v15
    v_accvgpr_read_b32 v252, a24
    s_waitcnt lgkmcnt(10)
    v_mfma_f32_32x32x16_bf16 a[32:47], a[140:143], v[36:39], a[32:47]
    ds_read_b128 a[184:187], v7 offset:57344
    ds_read_b128 a[188:191], v8 offset:57344
    v_accvgpr_read_b32 v253, a25
    v_max3_f32 v15, v252, v253, v15
    v_accvgpr_read_b32 v254, a26
    v_accvgpr_read_b32 v255, a27
    v_max3_f32 v15, v254, v255, v15
    v_accvgpr_read_b32 v252, a28
    v_accvgpr_read_b32 v253, a29
    v_max3_f32 v15, v252, v253, v15
    v_accvgpr_read_b32 v254, a30
    v_accvgpr_read_b32 v255, a31
    v_max3_f32 v15, v254, v255, v15
    v_fma_f32 v136, v136, s44, -v248
    v_fma_f32 v137, v137, s44, -v248
    s_waitcnt lgkmcnt(11)
    v_mfma_f32_32x32x16_bf16 a[32:47], a[144:147], v[40:43], a[32:47]
    v_fma_f32 v138, v138, s44, -v248
    v_fma_f32 v139, v139, s44, -v248
    v_exp_f32 v136, v136
    v_exp_f32 v137, v137
    v_fma_f32 v140, v140, s44, -v248
    v_fma_f32 v141, v141, s44, -v248
    v_exp_f32 v138, v138
    v_exp_f32 v139, v139
    v_add_f32 v250, v250, v136
    v_add_f32 v251, v251, v137
    v_fma_f32 v142, v142, s44, -v248
    v_fma_f32 v143, v143, s44, -v248
    v_exp_f32 v140, v140
    v_exp_f32 v141, v141
    s_waitcnt lgkmcnt(10)
    v_mfma_f32_32x32x16_bf16 a[32:47], a[148:151], v[44:47], a[32:47]
    v_add_f32 v250, v250, v138
    v_add_f32 v251, v251, v139
    v_cvt_pk_bf16_f32 v136, v136, v137
    v_fma_f32 v144, v144, s44, -v248
    v_fma_f32 v145, v145, s44, -v248
    v_exp_f32 v142, v142
    v_exp_f32 v143, v143
    v_add_f32 v250, v250, v140
    v_add_f32 v251, v251, v141
    v_cvt_pk_bf16_f32 v137, v138, v139
    v_fma_f32 v146, v146, s44, -v248
    v_fma_f32 v147, v147, s44, -v248
    v_exp_f32 v144, v144
    s_waitcnt lgkmcnt(9)
    v_mfma_f32_32x32x16_bf16 a[32:47], a[152:155], v[48:51], a[32:47]
    v_exp_f32 v145, v145
    v_add_f32 v250, v250, v142
    v_add_f32 v251, v251, v143
    v_cvt_pk_bf16_f32 v138, v140, v141
    v_fma_f32 v148, v148, s44, -v248
    v_fma_f32 v149, v149, s44, -v248
    v_exp_f32 v146, v146
    v_exp_f32 v147, v147
    v_add_f32 v250, v250, v144
    v_add_f32 v251, v251, v145
    v_cvt_pk_bf16_f32 v139, v142, v143
    v_fma_f32 v150, v150, s44, -v248
    v_fma_f32 v151, v151, s44, -v248
    s_waitcnt lgkmcnt(8)
    v_mfma_f32_32x32x16_bf16 a[32:47], a[156:159], v[52:55], a[32:47]
    v_exp_f32 v148, v148
    v_exp_f32 v149, v149
    v_add_f32 v250, v250, v146
    v_add_f32 v251, v251, v147
    v_cvt_pk_bf16_f32 v140, v144, v145
    v_exp_f32 v150, v150
    v_exp_f32 v151, v151
    v_add_f32 v250, v250, v148
    v_add_f32 v251, v251, v149
    v_cvt_pk_bf16_f32 v141, v146, v147
    v_add_f32 v250, v250, v150
    v_add_f32 v251, v251, v151
    v_cvt_pk_bf16_f32 v142, v148, v149
    v_cvt_pk_bf16_f32 v143, v150, v151
    s_waitcnt lgkmcnt(7)
    v_mfma_f32_32x32x16_bf16 a[48:63], a[160:163], v[24:27], 0
    s_waitcnt lgkmcnt(6)
    v_mfma_f32_32x32x16_bf16 a[48:63], a[164:167], v[28:31], a[48:63]
    s_waitcnt lgkmcnt(5)
    v_mfma_f32_32x32x16_bf16 a[48:63], a[168:171], v[32:35], a[48:63]
    v_accvgpr_read_b32 v252, a32
    v_accvgpr_read_b32 v253, a33
    v_max3_f32 v15, v252, v253, v15
    v_accvgpr_read_b32 v254, a34
    v_accvgpr_read_b32 v255, a35
    v_max3_f32 v15, v254, v255, v15
    v_accvgpr_read_b32 v252, a36
    v_accvgpr_read_b32 v253, a37
    v_max3_f32 v15, v252, v253, v15
    v_accvgpr_read_b32 v254, a38
    v_accvgpr_read_b32 v255, a39
    v_max3_f32 v15, v254, v255, v15
    v_accvgpr_read_b32 v252, a40
    s_waitcnt lgkmcnt(4)
    v_mfma_f32_32x32x16_bf16 a[48:63], a[172:175], v[36:39], a[48:63]
    v_accvgpr_read_b32 v253, a41
    v_max3_f32 v15, v252, v253, v15
    v_accvgpr_read_b32 v254, a42
    v_accvgpr_read_b32 v255, a43
    v_max3_f32 v15, v254, v255, v15
    v_accvgpr_read_b32 v252, a44
    v_accvgpr_read_b32 v253, a45
    v_max3_f32 v15, v252, v253, v15
    v_accvgpr_read_b32 v254, a46
    v_accvgpr_read_b32 v255, a47
    v_max3_f32 v15, v254, v255, v15
    v_fma_f32 v152, v152, s44, -v248
    v_fma_f32 v153, v153, s44, -v248
    s_waitcnt lgkmcnt(3)
    v_mfma_f32_32x32x16_bf16 a[48:63], a[176:179], v[40:43], a[48:63]
    v_fma_f32 v154, v154, s44, -v248
    v_fma_f32 v155, v155, s44, -v248
    v_exp_f32 v152, v152
    v_exp_f32 v153, v153
    v_fma_f32 v156, v156, s44, -v248
    v_fma_f32 v157, v157, s44, -v248
    v_exp_f32 v154, v154
    v_exp_f32 v155, v155
    v_add_f32 v250, v250, v152
    v_add_f32 v251, v251, v153
    v_fma_f32 v158, v158, s44, -v248
    v_fma_f32 v159, v159, s44, -v248
    v_exp_f32 v156, v156
    v_exp_f32 v157, v157
    s_waitcnt lgkmcnt(2)
    v_mfma_f32_32x32x16_bf16 a[48:63], a[180:183], v[44:47], a[48:63]
    v_add_f32 v250, v250, v154
    v_add_f32 v251, v251, v155
    v_cvt_pk_bf16_f32 v152, v152, v153
    v_fma_f32 v160, v160, s44, -v248
    v_fma_f32 v161, v161, s44, -v248
    v_exp_f32 v158, v158
    v_exp_f32 v159, v159
    v_add_f32 v250, v250, v156
    v_add_f32 v251, v251, v157
    v_cvt_pk_bf16_f32 v153, v154, v155
    v_fma_f32 v162, v162, s44, -v248
    v_fma_f32 v163, v163, s44, -v248
    v_exp_f32 v160, v160
    s_waitcnt lgkmcnt(1)
    v_mfma_f32_32x32x16_bf16 a[48:63], a[184:187], v[48:51], a[48:63]
    v_exp_f32 v161, v161
    v_add_f32 v250, v250, v158
    v_add_f32 v251, v251, v159
    v_cvt_pk_bf16_f32 v154, v156, v157
    v_fma_f32 v164, v164, s44, -v248
    v_fma_f32 v165, v165, s44, -v248
    v_exp_f32 v162, v162
    v_exp_f32 v163, v163
    v_add_f32 v250, v250, v160
    v_add_f32 v251, v251, v161
    v_cvt_pk_bf16_f32 v155, v158, v159
    v_fma_f32 v166, v166, s44, -v248
    v_fma_f32 v167, v167, s44, -v248
    s_waitcnt lgkmcnt(0)
    v_mfma_f32_32x32x16_bf16 a[48:63], a[188:191], v[52:55], a[48:63]
    v_exp_f32 v164, v164
    v_exp_f32 v165, v165
    v_add_f32 v250, v250, v162
    v_add_f32 v251, v251, v163
    v_cvt_pk_bf16_f32 v156, v160, v161
    v_exp_f32 v166, v166
    v_exp_f32 v167, v167
    v_add_f32 v250, v250, v164
    v_add_f32 v251, v251, v165
    v_cvt_pk_bf16_f32 v157, v162, v163
    v_add_f32 v250, v250, v166
    v_add_f32 v251, v251, v167
    v_cvt_pk_bf16_f32 v158, v164, v165
    v_cvt_pk_bf16_f32 v159, v166, v167
    v_fma_f32 v168, v168, s44, -v248
    v_fma_f32 v169, v169, s44, -v248
    v_fma_f32 v170, v170, s44, -v248
    v_fma_f32 v171, v171, s44, -v248
    v_exp_f32 v168, v168
    v_exp_f32 v169, v169
    v_fma_f32 v172, v172, s44, -v248
    v_fma_f32 v173, v173, s44, -v248
    v_exp_f32 v170, v170
    v_exp_f32 v171, v171
    v_add_f32 v250, v250, v168
    v_add_f32 v251, v251, v169
    v_accvgpr_read_b32 v252, a48
    v_accvgpr_read_b32 v253, a49
    v_max3_f32 v15, v252, v253, v15
    v_accvgpr_read_b32 v254, a50
    v_accvgpr_read_b32 v255, a51
    v_max3_f32 v15, v254, v255, v15
    v_accvgpr_read_b32 v252, a52
    v_accvgpr_read_b32 v253, a53
    v_max3_f32 v15, v252, v253, v15
    v_accvgpr_read_b32 v254, a54
    v_accvgpr_read_b32 v255, a55
    v_max3_f32 v15, v254, v255, v15
    v_accvgpr_read_b32 v252, a56
    v_accvgpr_read_b32 v253, a57
    v_max3_f32 v15, v252, v253, v15
    v_accvgpr_read_b32 v254, a58
    v_accvgpr_read_b32 v255, a59
    v_max3_f32 v15, v254, v255, v15
    v_accvgpr_read_b32 v252, a60
    v_accvgpr_read_b32 v253, a61
    v_max3_f32 v15, v252, v253, v15
    v_accvgpr_read_b32 v254, a62
    v_accvgpr_read_b32 v255, a63
    v_max3_f32 v15, v254, v255, v15
    v_fma_f32 v174, v174, s44, -v248
    v_fma_f32 v175, v175, s44, -v248
    v_exp_f32 v172, v172
    v_exp_f32 v173, v173
    v_add_f32 v250, v250, v170
    v_add_f32 v251, v251, v171
    v_cvt_pk_bf16_f32 v168, v168, v169
    v_fma_f32 v176, v176, s44, -v248
    v_fma_f32 v177, v177, s44, -v248
    v_exp_f32 v174, v174
    v_exp_f32 v175, v175
    v_add_f32 v250, v250, v172
    v_add_f32 v251, v251, v173
    v_cvt_pk_bf16_f32 v169, v170, v171
    v_fma_f32 v178, v178, s44, -v248
    v_fma_f32 v179, v179, s44, -v248
    v_exp_f32 v176, v176
    v_exp_f32 v177, v177
    v_add_f32 v250, v250, v174
    v_add_f32 v251, v251, v175
    v_cvt_pk_bf16_f32 v170, v172, v173
    v_fma_f32 v180, v180, s44, -v248
    v_fma_f32 v181, v181, s44, -v248
    v_exp_f32 v178, v178
    v_exp_f32 v179, v179
    v_add_f32 v250, v250, v176
    v_add_f32 v251, v251, v177
    v_cvt_pk_bf16_f32 v171, v174, v175
    v_fma_f32 v182, v182, s44, -v248
    v_fma_f32 v183, v183, s44, -v248
    v_exp_f32 v180, v180
    v_exp_f32 v181, v181
    v_add_f32 v250, v250, v178
    v_add_f32 v251, v251, v179
    v_cvt_pk_bf16_f32 v172, v176, v177
    v_exp_f32 v182, v182
    v_exp_f32 v183, v183
    v_add_f32 v250, v250, v180
    v_add_f32 v251, v251, v181
    v_cvt_pk_bf16_f32 v173, v178, v179
    v_add_f32 v250, v250, v182
    v_add_f32 v251, v251, v183
    v_cvt_pk_bf16_f32 v174, v180, v181
    v_cvt_pk_bf16_f32 v175, v182, v183
    v_mov_b32 v18, v15
    v_mov_b32 v19, v15
    s_nop 1
    v_permlane32_swap_b32 v18, v19
    v_max_f32 v15, v18, v19
    v_max_f32 v15, v14, v15
    v_mul_f32 v24, s44, v15
    v_mul_f32 v25, s44, v15
    v_sub_f32 v16, v248, v24
    v_exp_f32 v16, v16
    v_mov_b32 v26, 0
    v_mov_b32 v27, 0
    s_barrier
    ds_read_b64_tr_b16 a[128:129], v9 offset:0
    ds_read_b64_tr_b16 a[130:131], v9 offset:2048
    ds_read_b64_tr_b16 a[132:133], v10 offset:0
    ds_read_b64_tr_b16 a[134:135], v10 offset:2048
    ds_read_b64_tr_b16 a[136:137], v11 offset:0
    ds_read_b64_tr_b16 a[138:139], v11 offset:2048
    ds_read_b64_tr_b16 a[140:141], v12 offset:0
    ds_read_b64_tr_b16 a[142:143], v12 offset:2048
    ds_read_b64_tr_b16 a[144:145], v9 offset:4096
    ds_read_b64_tr_b16 a[146:147], v9 offset:6144
    ds_read_b64_tr_b16 a[148:149], v10 offset:4096
    ds_read_b64_tr_b16 a[150:151], v10 offset:6144
    ds_read_b64_tr_b16 a[152:153], v11 offset:4096
    ds_read_b64_tr_b16 a[154:155], v11 offset:6144
    ds_read_b64_tr_b16 a[156:157], v12 offset:4096
    ds_read_b64_tr_b16 a[158:159], v12 offset:6144
    s_waitcnt lgkmcnt(14)
    v_mfma_f32_32x32x16_bf16 a[64:79], a[128:131], v[56:59], 0
    ds_read_b64_tr_b16 a[160:161], v9 offset:8192
    ds_read_b64_tr_b16 a[162:163], v9 offset:10240
    ds_read_b64_tr_b16 a[164:165], v10 offset:8192
    ds_read_b64_tr_b16 a[166:167], v10 offset:10240
    ds_read_b64_tr_b16 a[168:169], v11 offset:8192
    ds_read_b64_tr_b16 a[170:171], v11 offset:10240
    ds_read_b64_tr_b16 a[172:173], v12 offset:8192
    ds_read_b64_tr_b16 a[174:175], v12 offset:10240
    s_waitcnt lgkmcnt(15)
    v_mfma_f32_32x32x16_bf16 a[80:95], a[132:135], v[56:59], 0
    v_fma_f32 v184, v184, s44, -v24
    v_fma_f32 v185, v185, s44, -v24
    v_fma_f32 v186, v186, s44, -v24
    v_fma_f32 v187, v187, s44, -v24
    v_exp_f32 v184, v184
    v_exp_f32 v185, v185
    v_fma_f32 v188, v188, s44, -v24
    v_fma_f32 v189, v189, s44, -v24
    v_mfma_f32_32x32x16_bf16 a[96:111], a[136:139], v[56:59], 0
    v_exp_f32 v186, v186
    v_exp_f32 v187, v187
    v_add_f32 v26, v26, v184
    v_add_f32 v27, v27, v185
    v_fma_f32 v190, v190, s44, -v24
    v_fma_f32 v191, v191, s44, -v24
    v_exp_f32 v188, v188
    v_exp_f32 v189, v189
    v_mfma_f32_32x32x16_bf16 a[112:127], a[140:143], v[56:59], 0
    v_add_f32 v26, v26, v186
    v_add_f32 v27, v27, v187
    v_cvt_pk_bf16_f32 v184, v184, v185
    v_fma_f32 v192, v192, s44, -v24
    v_fma_f32 v193, v193, s44, -v24
    v_exp_f32 v190, v190
    v_exp_f32 v191, v191
    v_add_f32 v26, v26, v188
    v_add_f32 v27, v27, v189
    s_waitcnt lgkmcnt(14)
    v_mfma_f32_32x32x16_bf16 a[64:79], a[144:147], v[60:63], a[64:79]
    ds_read_b64_tr_b16 a[176:177], v9 offset:12288
    ds_read_b64_tr_b16 a[178:179], v9 offset:14336
    ds_read_b64_tr_b16 a[180:181], v10 offset:12288
    ds_read_b64_tr_b16 a[182:183], v10 offset:14336
    ds_read_b64_tr_b16 a[184:185], v11 offset:12288
    ds_read_b64_tr_b16 a[186:187], v11 offset:14336
    ds_read_b64_tr_b16 a[188:189], v12 offset:12288
    ds_read_b64_tr_b16 a[190:191], v12 offset:14336
    s_waitcnt lgkmcnt(15)
    v_mfma_f32_32x32x16_bf16 a[80:95], a[148:151], v[60:63], a[80:95]
    v_cvt_pk_bf16_f32 v185, v186, v187
    v_fma_f32 v194, v194, s44, -v24
    v_fma_f32 v195, v195, s44, -v24
    v_exp_f32 v192, v192
    v_exp_f32 v193, v193
    v_add_f32 v26, v26, v190
    v_add_f32 v27, v27, v191
    v_cvt_pk_bf16_f32 v186, v188, v189
    v_fma_f32 v196, v196, s44, -v24
    v_mfma_f32_32x32x16_bf16 a[96:111], a[152:155], v[60:63], a[96:111]
    v_fma_f32 v197, v197, s44, -v24
    v_exp_f32 v194, v194
    v_exp_f32 v195, v195
    v_add_f32 v26, v26, v192
    v_add_f32 v27, v27, v193
    v_cvt_pk_bf16_f32 v187, v190, v191
    v_fma_f32 v198, v198, s44, -v24
    v_fma_f32 v199, v199, s44, -v24
    v_mfma_f32_32x32x16_bf16 a[112:127], a[156:159], v[60:63], a[112:127]
    v_exp_f32 v196, v196
    v_exp_f32 v197, v197
    v_add_f32 v26, v26, v194
    v_add_f32 v27, v27, v195
    v_cvt_pk_bf16_f32 v188, v192, v193
    v_exp_f32 v198, v198
    v_exp_f32 v199, v199
    v_add_f32 v26, v26, v196
    v_add_f32 v27, v27, v197
    v_add_u32 v9, 0x4000, v9
    v_add_u32 v10, 0x4000, v10
    v_add_u32 v11, 0x4000, v11
    v_add_u32 v12, 0x4000, v12
    s_waitcnt lgkmcnt(14)
    v_mfma_f32_32x32x16_bf16 a[64:79], a[160:163], v[72:75], a[64:79]
    ds_read_b64_tr_b16 a[128:129], v9 offset:0
    ds_read_b64_tr_b16 a[130:131], v9 offset:2048
    ds_read_b64_tr_b16 a[132:133], v10 offset:0
    ds_read_b64_tr_b16 a[134:135], v10 offset:2048
    ds_read_b64_tr_b16 a[136:137], v11 offset:0
    ds_read_b64_tr_b16 a[138:139], v11 offset:2048
    ds_read_b64_tr_b16 a[140:141], v12 offset:0
    ds_read_b64_tr_b16 a[142:143], v12 offset:2048
    s_waitcnt lgkmcnt(15)
    v_mfma_f32_32x32x16_bf16 a[80:95], a[164:167], v[72:75], a[80:95]
    v_cvt_pk_bf16_f32 v189, v194, v195
    v_add_f32 v26, v26, v198
    v_add_f32 v27, v27, v199
    v_cvt_pk_bf16_f32 v190, v196, v197
    v_cvt_pk_bf16_f32 v191, v198, v199
    v_fma_f32 v200, v200, s44, -v24
    v_fma_f32 v201, v201, s44, -v24
    v_fma_f32 v202, v202, s44, -v24
    v_fma_f32 v203, v203, s44, -v24
    v_mfma_f32_32x32x16_bf16 a[96:111], a[168:171], v[72:75], a[96:111]
    v_exp_f32 v200, v200
    v_exp_f32 v201, v201
    v_fma_f32 v204, v204, s44, -v24
    v_fma_f32 v205, v205, s44, -v24
    v_exp_f32 v202, v202
    v_exp_f32 v203, v203
    v_add_f32 v26, v26, v200
    v_add_f32 v27, v27, v201
    v_mfma_f32_32x32x16_bf16 a[112:127], a[172:175], v[72:75], a[112:127]
    v_fma_f32 v206, v206, s44, -v24
    v_fma_f32 v207, v207, s44, -v24
    v_exp_f32 v204, v204
    v_exp_f32 v205, v205
    v_add_f32 v26, v26, v202
    v_add_f32 v27, v27, v203
    v_cvt_pk_bf16_f32 v200, v200, v201
    v_fma_f32 v208, v208, s44, -v24
    v_fma_f32 v209, v209, s44, -v24
    s_waitcnt lgkmcnt(14)
    v_mfma_f32_32x32x16_bf16 a[64:79], a[176:179], v[76:79], a[64:79]
    ds_read_b64_tr_b16 a[144:145], v9 offset:4096
    ds_read_b64_tr_b16 a[146:147], v9 offset:6144
    ds_read_b64_tr_b16 a[148:149], v10 offset:4096
    ds_read_b64_tr_b16 a[150:151], v10 offset:6144
    ds_read_b64_tr_b16 a[152:153], v11 offset:4096
    ds_read_b64_tr_b16 a[154:155], v11 offset:6144
    ds_read_b64_tr_b16 a[156:157], v12 offset:4096
    ds_read_b64_tr_b16 a[158:159], v12 offset:6144
    s_waitcnt lgkmcnt(15)
    v_mfma_f32_32x32x16_bf16 a[80:95], a[180:183], v[76:79], a[80:95]
    v_exp_f32 v206, v206
    v_exp_f32 v207, v207
    v_add_f32 v26, v26, v204
    v_add_f32 v27, v27, v205
    v_cvt_pk_bf16_f32 v201, v202, v203
    v_fma_f32 v210, v210, s44, -v24
    v_fma_f32 v211, v211, s44, -v24
    v_exp_f32 v208, v208
    v_exp_f32 v209, v209
    v_mfma_f32_32x32x16_bf16 a[96:111], a[184:187], v[76:79], a[96:111]
    v_add_f32 v26, v26, v206
    v_add_f32 v27, v27, v207
    v_cvt_pk_bf16_f32 v202, v204, v205
    v_fma_f32 v212, v212, s44, -v24
    v_fma_f32 v213, v213, s44, -v24
    v_exp_f32 v210, v210
    v_exp_f32 v211, v211
    v_add_f32 v26, v26, v208
    v_mfma_f32_32x32x16_bf16 a[112:127], a[188:191], v[76:79], a[112:127]
    v_add_f32 v27, v27, v209
    v_cvt_pk_bf16_f32 v203, v206, v207
    v_fma_f32 v214, v214, s44, -v24
    v_fma_f32 v215, v215, s44, -v24
    v_exp_f32 v212, v212
    v_exp_f32 v213, v213
    v_add_f32 v26, v26, v210
    v_add_f32 v27, v27, v211
    v_cvt_pk_bf16_f32 v204, v208, v209
    s_waitcnt lgkmcnt(14)
    v_mfma_f32_32x32x16_bf16 a[64:79], a[128:131], v[88:91], a[64:79]
    ds_read_b64_tr_b16 a[160:161], v9 offset:8192
    ds_read_b64_tr_b16 a[162:163], v9 offset:10240
    ds_read_b64_tr_b16 a[164:165], v10 offset:8192
    ds_read_b64_tr_b16 a[166:167], v10 offset:10240
    ds_read_b64_tr_b16 a[168:169], v11 offset:8192
    ds_read_b64_tr_b16 a[170:171], v11 offset:10240
    ds_read_b64_tr_b16 a[172:173], v12 offset:8192
    ds_read_b64_tr_b16 a[174:175], v12 offset:10240
    s_waitcnt lgkmcnt(15)
    v_mfma_f32_32x32x16_bf16 a[80:95], a[132:135], v[88:91], a[80:95]
    v_exp_f32 v214, v214
    v_exp_f32 v215, v215
    v_add_f32 v26, v26, v212
    v_add_f32 v27, v27, v213
    v_cvt_pk_bf16_f32 v205, v210, v211
    v_add_f32 v26, v26, v214
    v_add_f32 v27, v27, v215
    v_cvt_pk_bf16_f32 v206, v212, v213
    v_mfma_f32_32x32x16_bf16 a[96:111], a[136:139], v[88:91], a[96:111]
    v_cvt_pk_bf16_f32 v207, v214, v215
    v_fma_f32 v216, v216, s44, -v24
    v_fma_f32 v217, v217, s44, -v24
    v_fma_f32 v218, v218, s44, -v24
    v_fma_f32 v219, v219, s44, -v24
    v_exp_f32 v216, v216
    v_exp_f32 v217, v217
    v_fma_f32 v220, v220, s44, -v24
    v_mfma_f32_32x32x16_bf16 a[112:127], a[140:143], v[88:91], a[112:127]
    v_fma_f32 v221, v221, s44, -v24
    v_exp_f32 v218, v218
    v_exp_f32 v219, v219
    v_add_f32 v26, v26, v216
    v_add_f32 v27, v27, v217
    v_fma_f32 v222, v222, s44, -v24
    v_fma_f32 v223, v223, s44, -v24
    v_exp_f32 v220, v220
    v_exp_f32 v221, v221
    s_waitcnt lgkmcnt(14)
    v_mfma_f32_32x32x16_bf16 a[64:79], a[144:147], v[92:95], a[64:79]
    ds_read_b64_tr_b16 a[176:177], v9 offset:12288
    ds_read_b64_tr_b16 a[178:179], v9 offset:14336
    ds_read_b64_tr_b16 a[180:181], v10 offset:12288
    ds_read_b64_tr_b16 a[182:183], v10 offset:14336
    ds_read_b64_tr_b16 a[184:185], v11 offset:12288
    ds_read_b64_tr_b16 a[186:187], v11 offset:14336
    ds_read_b64_tr_b16 a[188:189], v12 offset:12288
    ds_read_b64_tr_b16 a[190:191], v12 offset:14336
    s_waitcnt lgkmcnt(15)
    v_mfma_f32_32x32x16_bf16 a[80:95], a[148:151], v[92:95], a[80:95]
    v_add_f32 v26, v26, v218
    v_add_f32 v27, v27, v219
    v_cvt_pk_bf16_f32 v216, v216, v217
    v_fma_f32 v224, v224, s44, -v24
    v_fma_f32 v225, v225, s44, -v24
    v_exp_f32 v222, v222
    v_exp_f32 v223, v223
    v_add_f32 v26, v26, v220
    v_add_f32 v27, v27, v221
    v_mfma_f32_32x32x16_bf16 a[96:111], a[152:155], v[92:95], a[96:111]
    v_cvt_pk_bf16_f32 v217, v218, v219
    v_fma_f32 v226, v226, s44, -v24
    v_fma_f32 v227, v227, s44, -v24
    v_exp_f32 v224, v224
    v_exp_f32 v225, v225
    v_add_f32 v26, v26, v222
    v_add_f32 v27, v27, v223
    v_cvt_pk_bf16_f32 v218, v220, v221
    v_mfma_f32_32x32x16_bf16 a[112:127], a[156:159], v[92:95], a[112:127]
    v_fma_f32 v228, v228, s44, -v24
    v_fma_f32 v229, v229, s44, -v24
    v_exp_f32 v226, v226
    v_exp_f32 v227, v227
    v_add_f32 v26, v26, v224
    v_add_f32 v27, v27, v225
    v_cvt_pk_bf16_f32 v219, v222, v223
    v_fma_f32 v230, v230, s44, -v24
    v_fma_f32 v231, v231, s44, -v24
    s_barrier
    v_add_u32 v9, 0xfffdc000, v9
    v_add_u32 v10, 0xfffdc000, v10
    v_add_u32 v11, 0xfffdc000, v11
    v_add_u32 v12, 0xfffdc000, v12
    s_waitcnt lgkmcnt(14)
    v_mfma_f32_32x32x16_bf16 a[64:79], a[160:163], v[104:107], a[64:79]
    ds_read_b64_tr_b16 a[128:129], v9 offset:0
    ds_read_b64_tr_b16 a[130:131], v9 offset:2048
    ds_read_b64_tr_b16 a[132:133], v10 offset:0
    ds_read_b64_tr_b16 a[134:135], v10 offset:2048
    ds_read_b64_tr_b16 a[136:137], v11 offset:0
    ds_read_b64_tr_b16 a[138:139], v11 offset:2048
    ds_read_b64_tr_b16 a[140:141], v12 offset:0
    ds_read_b64_tr_b16 a[142:143], v12 offset:2048
    s_waitcnt lgkmcnt(15)
    v_mfma_f32_32x32x16_bf16 a[80:95], a[164:167], v[104:107], a[80:95]
    v_exp_f32 v228, v228
    v_exp_f32 v229, v229
    v_add_f32 v26, v26, v226
    v_add_f32 v27, v27, v227
    v_cvt_pk_bf16_f32 v220, v224, v225
    v_exp_f32 v230, v230
    v_exp_f32 v231, v231
    v_add_f32 v26, v26, v228
    v_add_f32 v27, v27, v229
    v_mfma_f32_32x32x16_bf16 a[96:111], a[168:171], v[104:107], a[96:111]
    v_cvt_pk_bf16_f32 v221, v226, v227
    v_add_f32 v26, v26, v230
    v_add_f32 v27, v27, v231
    v_cvt_pk_bf16_f32 v222, v228, v229
    v_cvt_pk_bf16_f32 v223, v230, v231
    v_fma_f32 v232, v232, s44, -v24
    v_fma_f32 v233, v233, s44, -v24
    v_fma_f32 v234, v234, s44, -v24
    v_mfma_f32_32x32x16_bf16 a[112:127], a[172:175], v[104:107], a[112:127]
    v_fma_f32 v235, v235, s44, -v24
    v_exp_f32 v232, v232
    v_exp_f32 v233, v233
    v_fma_f32 v236, v236, s44, -v24
    v_fma_f32 v237, v237, s44, -v24
    v_exp_f32 v234, v234
    v_exp_f32 v235, v235
    v_add_f32 v26, v26, v232
    v_add_f32 v27, v27, v233
    s_waitcnt lgkmcnt(14)
    v_mfma_f32_32x32x16_bf16 a[64:79], a[176:179], v[108:111], a[64:79]
    ds_read_b64_tr_b16 a[144:145], v9 offset:4096
    ds_read_b64_tr_b16 a[146:147], v9 offset:6144
    ds_read_b64_tr_b16 a[148:149], v10 offset:4096
    ds_read_b64_tr_b16 a[150:151], v10 offset:6144
    ds_read_b64_tr_b16 a[152:153], v11 offset:4096
    ds_read_b64_tr_b16 a[154:155], v11 offset:6144
    ds_read_b64_tr_b16 a[156:157], v12 offset:4096
    ds_read_b64_tr_b16 a[158:159], v12 offset:6144
    s_waitcnt lgkmcnt(15)
    v_mfma_f32_32x32x16_bf16 a[80:95], a[180:183], v[108:111], a[80:95]
    v_fma_f32 v238, v238, s44, -v24
    v_fma_f32 v239, v239, s44, -v24
    v_exp_f32 v236, v236
    v_exp_f32 v237, v237
    v_add_f32 v26, v26, v234
    v_add_f32 v27, v27, v235
    v_cvt_pk_bf16_f32 v232, v232, v233
    v_fma_f32 v240, v240, s44, -v24
    v_fma_f32 v241, v241, s44, -v24
    v_mfma_f32_32x32x16_bf16 a[96:111], a[184:187], v[108:111], a[96:111]
    v_exp_f32 v238, v238
    v_exp_f32 v239, v239
    v_add_f32 v26, v26, v236
    v_add_f32 v27, v27, v237
    v_cvt_pk_bf16_f32 v233, v234, v235
    v_fma_f32 v242, v242, s44, -v24
    v_fma_f32 v243, v243, s44, -v24
    v_exp_f32 v240, v240
    v_mfma_f32_32x32x16_bf16 a[112:127], a[188:191], v[108:111], a[112:127]
    v_exp_f32 v241, v241
    v_add_f32 v26, v26, v238
    v_add_f32 v27, v27, v239
    v_cvt_pk_bf16_f32 v234, v236, v237
    v_fma_f32 v244, v244, s44, -v24
    v_fma_f32 v245, v245, s44, -v24
    v_exp_f32 v242, v242
    v_exp_f32 v243, v243
    v_add_f32 v26, v26, v240
    s_waitcnt lgkmcnt(14)
    v_mfma_f32_32x32x16_bf16 a[64:79], a[128:131], v[120:123], a[64:79]
    ds_read_b64_tr_b16 a[160:161], v9 offset:8192
    ds_read_b64_tr_b16 a[162:163], v9 offset:10240
    ds_read_b64_tr_b16 a[164:165], v10 offset:8192
    ds_read_b64_tr_b16 a[166:167], v10 offset:10240
    ds_read_b64_tr_b16 a[168:169], v11 offset:8192
    ds_read_b64_tr_b16 a[170:171], v11 offset:10240
    ds_read_b64_tr_b16 a[172:173], v12 offset:8192
    ds_read_b64_tr_b16 a[174:175], v12 offset:10240
    s_waitcnt lgkmcnt(15)
    v_mfma_f32_32x32x16_bf16 a[80:95], a[132:135], v[120:123], a[80:95]
    v_add_f32 v27, v27, v241
    v_cvt_pk_bf16_f32 v235, v238, v239
    v_fma_f32 v246, v246, s44, -v24
    v_fma_f32 v247, v247, s44, -v24
    v_exp_f32 v244, v244
    v_exp_f32 v245, v245
    v_add_f32 v26, v26, v242
    v_add_f32 v27, v27, v243
    v_mfma_f32_32x32x16_bf16 a[96:111], a[136:139], v[120:123], a[96:111]
    v_cvt_pk_bf16_f32 v236, v240, v241
    v_exp_f32 v246, v246
    v_exp_f32 v247, v247
    v_add_f32 v26, v26, v244
    v_add_f32 v27, v27, v245
    v_cvt_pk_bf16_f32 v237, v242, v243
    v_add_f32 v26, v26, v246
    v_add_f32 v27, v27, v247
    v_mfma_f32_32x32x16_bf16 a[112:127], a[140:143], v[120:123], a[112:127]
    v_cvt_pk_bf16_f32 v238, v244, v245
    v_cvt_pk_bf16_f32 v239, v246, v247
    v_accvgpr_read_b32 v64, a0
    v_accvgpr_read_b32 v65, a1
    v_fma_f32 v64, v64, s44, -v24
    v_fma_f32 v65, v65, s44, -v24
    v_accvgpr_read_b32 v66, a2
    v_accvgpr_read_b32 v67, a3
    v_fma_f32 v66, v66, s44, -v24
    s_waitcnt lgkmcnt(14)
    v_mfma_f32_32x32x16_bf16 a[64:79], a[144:147], v[124:127], a[64:79]
    ds_read_b64_tr_b16 a[176:177], v9 offset:12288
    ds_read_b64_tr_b16 a[178:179], v9 offset:14336
    ds_read_b64_tr_b16 a[180:181], v10 offset:12288
    ds_read_b64_tr_b16 a[182:183], v10 offset:14336
    ds_read_b64_tr_b16 a[184:185], v11 offset:12288
    ds_read_b64_tr_b16 a[186:187], v11 offset:14336
    ds_read_b64_tr_b16 a[188:189], v12 offset:12288
    ds_read_b64_tr_b16 a[190:191], v12 offset:14336
    s_waitcnt lgkmcnt(15)
    v_mfma_f32_32x32x16_bf16 a[80:95], a[148:151], v[124:127], a[80:95]
    v_fma_f32 v67, v67, s44, -v24
    v_exp_f32 v64, v64
    v_exp_f32 v65, v65
    v_accvgpr_read_b32 v68, a4
    v_accvgpr_read_b32 v69, a5
    v_fma_f32 v68, v68, s44, -v24
    v_fma_f32 v69, v69, s44, -v24
    v_exp_f32 v66, v66
    v_exp_f32 v67, v67
    v_mfma_f32_32x32x16_bf16 a[96:111], a[152:155], v[124:127], a[96:111]
    v_add_f32 v26, v26, v64
    v_add_f32 v27, v27, v65
    v_accvgpr_read_b32 v70, a6
    v_accvgpr_read_b32 v71, a7
    v_fma_f32 v70, v70, s44, -v24
    v_fma_f32 v71, v71, s44, -v24
    v_exp_f32 v68, v68
    v_exp_f32 v69, v69
    v_mfma_f32_32x32x16_bf16 a[112:127], a[156:159], v[124:127], a[112:127]
    v_add_f32 v26, v26, v66
    v_add_f32 v27, v27, v67
    v_cvt_pk_bf16_f32 v64, v64, v65
    v_accvgpr_read_b32 v80, a8
    v_accvgpr_read_b32 v81, a9
    v_fma_f32 v80, v80, s44, -v24
    v_fma_f32 v81, v81, s44, -v24
    v_exp_f32 v70, v70
    v_exp_f32 v71, v71
    v_add_u32 v9, 0x4000, v9
    v_add_u32 v10, 0x4000, v10
    v_add_u32 v11, 0x4000, v11
    v_add_u32 v12, 0x4000, v12
    s_waitcnt lgkmcnt(14)
    v_mfma_f32_32x32x16_bf16 a[64:79], a[160:163], v[136:139], a[64:79]
    ds_read_b64_tr_b16 a[128:129], v9 offset:0
    ds_read_b64_tr_b16 a[130:131], v9 offset:2048
    ds_read_b64_tr_b16 a[132:133], v10 offset:0
    ds_read_b64_tr_b16 a[134:135], v10 offset:2048
    ds_read_b64_tr_b16 a[136:137], v11 offset:0
    ds_read_b64_tr_b16 a[138:139], v11 offset:2048
    ds_read_b64_tr_b16 a[140:141], v12 offset:0
    ds_read_b64_tr_b16 a[142:143], v12 offset:2048
    s_waitcnt lgkmcnt(15)
    v_mfma_f32_32x32x16_bf16 a[80:95], a[164:167], v[136:139], a[80:95]
    v_add_f32 v26, v26, v68
    v_add_f32 v27, v27, v69
    v_cvt_pk_bf16_f32 v65, v66, v67
    v_accvgpr_read_b32 v82, a10
    v_accvgpr_read_b32 v83, a11
    v_fma_f32 v82, v82, s44, -v24
    v_fma_f32 v83, v83, s44, -v24
    v_exp_f32 v80, v80
    v_exp_f32 v81, v81
    v_mfma_f32_32x32x16_bf16 a[96:111], a[168:171], v[136:139], a[96:111]
    v_add_f32 v26, v26, v70
    v_add_f32 v27, v27, v71
    v_cvt_pk_bf16_f32 v66, v68, v69
    v_accvgpr_read_b32 v84, a12
    v_accvgpr_read_b32 v85, a13
    v_fma_f32 v84, v84, s44, -v24
    v_fma_f32 v85, v85, s44, -v24
    v_exp_f32 v82, v82
    v_mfma_f32_32x32x16_bf16 a[112:127], a[172:175], v[136:139], a[112:127]
    v_exp_f32 v83, v83
    v_add_f32 v26, v26, v80
    v_add_f32 v27, v27, v81
    v_cvt_pk_bf16_f32 v67, v70, v71
    v_accvgpr_read_b32 v86, a14
    v_accvgpr_read_b32 v87, a15
    v_fma_f32 v86, v86, s44, -v24
    v_fma_f32 v87, v87, s44, -v24
    v_exp_f32 v84, v84
    s_waitcnt lgkmcnt(14)
    v_mfma_f32_32x32x16_bf16 a[64:79], a[176:179], v[140:143], a[64:79]
    ds_read_b64_tr_b16 a[144:145], v9 offset:4096
    ds_read_b64_tr_b16 a[146:147], v9 offset:6144
    ds_read_b64_tr_b16 a[148:149], v10 offset:4096
    ds_read_b64_tr_b16 a[150:151], v10 offset:6144
    ds_read_b64_tr_b16 a[152:153], v11 offset:4096
    ds_read_b64_tr_b16 a[154:155], v11 offset:6144
    ds_read_b64_tr_b16 a[156:157], v12 offset:4096
    ds_read_b64_tr_b16 a[158:159], v12 offset:6144
    s_waitcnt lgkmcnt(15)
    v_mfma_f32_32x32x16_bf16 a[80:95], a[180:183], v[140:143], a[80:95]
    v_exp_f32 v85, v85
    v_add_f32 v26, v26, v82
    v_add_f32 v27, v27, v83
    v_cvt_pk_bf16_f32 v80, v80, v81
    v_exp_f32 v86, v86
    v_exp_f32 v87, v87
    v_add_f32 v26, v26, v84
    v_add_f32 v27, v27, v85
    v_cvt_pk_bf16_f32 v81, v82, v83
    v_mfma_f32_32x32x16_bf16 a[96:111], a[184:187], v[140:143], a[96:111]
    v_add_f32 v26, v26, v86
    v_add_f32 v27, v27, v87
    v_cvt_pk_bf16_f32 v82, v84, v85
    v_cvt_pk_bf16_f32 v83, v86, v87
    v_accvgpr_read_b32 v96, a16
    v_accvgpr_read_b32 v97, a17
    v_fma_f32 v96, v96, s44, -v24
    v_fma_f32 v97, v97, s44, -v24
    v_mfma_f32_32x32x16_bf16 a[112:127], a[188:191], v[140:143], a[112:127]
    v_accvgpr_read_b32 v98, a18
    v_accvgpr_read_b32 v99, a19
    v_fma_f32 v98, v98, s44, -v24
    v_fma_f32 v99, v99, s44, -v24
    v_exp_f32 v96, v96
    v_exp_f32 v97, v97
    v_accvgpr_read_b32 v100, a20
    v_accvgpr_read_b32 v101, a21
    v_fma_f32 v100, v100, s44, -v24
    s_waitcnt lgkmcnt(14)
    v_mfma_f32_32x32x16_bf16 a[64:79], a[128:131], v[152:155], a[64:79]
    ds_read_b64_tr_b16 a[160:161], v9 offset:8192
    ds_read_b64_tr_b16 a[162:163], v9 offset:10240
    ds_read_b64_tr_b16 a[164:165], v10 offset:8192
    ds_read_b64_tr_b16 a[166:167], v10 offset:10240
    ds_read_b64_tr_b16 a[168:169], v11 offset:8192
    ds_read_b64_tr_b16 a[170:171], v11 offset:10240
    ds_read_b64_tr_b16 a[172:173], v12 offset:8192
    ds_read_b64_tr_b16 a[174:175], v12 offset:10240
    s_waitcnt lgkmcnt(15)
    v_mfma_f32_32x32x16_bf16 a[80:95], a[132:135], v[152:155], a[80:95]
    v_fma_f32 v101, v101, s44, -v24
    v_exp_f32 v98, v98
    v_exp_f32 v99, v99
    v_add_f32 v26, v26, v96
    v_add_f32 v27, v27, v97
    v_accvgpr_read_b32 v102, a22
    v_accvgpr_read_b32 v103, a23
    v_fma_f32 v102, v102, s44, -v24
    v_mfma_f32_32x32x16_bf16 a[96:111], a[136:139], v[152:155], a[96:111]
    v_fma_f32 v103, v103, s44, -v24
    v_exp_f32 v100, v100
    v_exp_f32 v101, v101
    v_add_f32 v26, v26, v98
    v_add_f32 v27, v27, v99
    v_cvt_pk_bf16_f32 v96, v96, v97
    v_accvgpr_read_b32 v112, a24
    v_accvgpr_read_b32 v113, a25
    v_mfma_f32_32x32x16_bf16 a[112:127], a[140:143], v[152:155], a[112:127]
    v_fma_f32 v112, v112, s44, -v24
    v_fma_f32 v113, v113, s44, -v24
    v_exp_f32 v102, v102
    v_exp_f32 v103, v103
    v_add_f32 v26, v26, v100
    v_add_f32 v27, v27, v101
    v_cvt_pk_bf16_f32 v97, v98, v99
    v_accvgpr_read_b32 v114, a26
    v_accvgpr_read_b32 v115, a27
    s_waitcnt lgkmcnt(14)
    v_mfma_f32_32x32x16_bf16 a[64:79], a[144:147], v[156:159], a[64:79]
    ds_read_b64_tr_b16 a[176:177], v9 offset:12288
    ds_read_b64_tr_b16 a[178:179], v9 offset:14336
    ds_read_b64_tr_b16 a[180:181], v10 offset:12288
    ds_read_b64_tr_b16 a[182:183], v10 offset:14336
    ds_read_b64_tr_b16 a[184:185], v11 offset:12288
    ds_read_b64_tr_b16 a[186:187], v11 offset:14336
    ds_read_b64_tr_b16 a[188:189], v12 offset:12288
    ds_read_b64_tr_b16 a[190:191], v12 offset:14336
    s_waitcnt lgkmcnt(15)
    v_mfma_f32_32x32x16_bf16 a[80:95], a[148:151], v[156:159], a[80:95]
    v_fma_f32 v114, v114, s44, -v24
    v_fma_f32 v115, v115, s44, -v24
    v_exp_f32 v112, v112
    v_exp_f32 v113, v113
    v_add_f32 v26, v26, v102
    v_add_f32 v27, v27, v103
    v_cvt_pk_bf16_f32 v98, v100, v101
    v_accvgpr_read_b32 v116, a28
    v_accvgpr_read_b32 v117, a29
    v_mfma_f32_32x32x16_bf16 a[96:111], a[152:155], v[156:159], a[96:111]
    v_fma_f32 v116, v116, s44, -v24
    v_fma_f32 v117, v117, s44, -v24
    v_exp_f32 v114, v114
    v_exp_f32 v115, v115
    v_add_f32 v26, v26, v112
    v_add_f32 v27, v27, v113
    v_cvt_pk_bf16_f32 v99, v102, v103
    v_accvgpr_read_b32 v118, a30
    v_mfma_f32_32x32x16_bf16 a[112:127], a[156:159], v[156:159], a[112:127]
    v_accvgpr_read_b32 v119, a31
    v_fma_f32 v118, v118, s44, -v24
    v_fma_f32 v119, v119, s44, -v24
    v_exp_f32 v116, v116
    v_exp_f32 v117, v117
    v_add_f32 v26, v26, v114
    v_add_f32 v27, v27, v115
    v_cvt_pk_bf16_f32 v112, v112, v113
    v_exp_f32 v118, v118
    s_barrier
    v_add_u32 v9, 0x4000, v9
    v_add_u32 v10, 0x4000, v10
    v_add_u32 v11, 0x4000, v11
    v_add_u32 v12, 0x4000, v12
    s_waitcnt lgkmcnt(14)
    v_mfma_f32_32x32x16_bf16 a[64:79], a[160:163], v[168:171], a[64:79]
    ds_read_b64_tr_b16 a[128:129], v9 offset:0
    ds_read_b64_tr_b16 a[130:131], v9 offset:2048
    ds_read_b64_tr_b16 a[132:133], v10 offset:0
    ds_read_b64_tr_b16 a[134:135], v10 offset:2048
    ds_read_b64_tr_b16 a[136:137], v11 offset:0
    ds_read_b64_tr_b16 a[138:139], v11 offset:2048
    ds_read_b64_tr_b16 a[140:141], v12 offset:0
    ds_read_b64_tr_b16 a[142:143], v12 offset:2048
    s_waitcnt lgkmcnt(15)
    v_mfma_f32_32x32x16_bf16 a[80:95], a[164:167], v[168:171], a[80:95]
    v_exp_f32 v119, v119
    v_add_f32 v26, v26, v116
    v_add_f32 v27, v27, v117
    v_cvt_pk_bf16_f32 v113, v114, v115
    v_add_f32 v26, v26, v118
    v_add_f32 v27, v27, v119
    v_cvt_pk_bf16_f32 v114, v116, v117
    v_cvt_pk_bf16_f32 v115, v118, v119
    v_accvgpr_read_b32 v128, a32
    v_mfma_f32_32x32x16_bf16 a[96:111], a[168:171], v[168:171], a[96:111]
    v_accvgpr_read_b32 v129, a33
    v_fma_f32 v128, v128, s44, -v24
    v_fma_f32 v129, v129, s44, -v24
    v_accvgpr_read_b32 v130, a34
    v_accvgpr_read_b32 v131, a35
    v_fma_f32 v130, v130, s44, -v24
    v_fma_f32 v131, v131, s44, -v24
    v_exp_f32 v128, v128
    v_mfma_f32_32x32x16_bf16 a[112:127], a[172:175], v[168:171], a[112:127]
    v_exp_f32 v129, v129
    v_accvgpr_read_b32 v132, a36
    v_accvgpr_read_b32 v133, a37
    v_fma_f32 v132, v132, s44, -v24
    v_fma_f32 v133, v133, s44, -v24
    v_exp_f32 v130, v130
    v_exp_f32 v131, v131
    v_add_f32 v26, v26, v128
    v_add_f32 v27, v27, v129
    s_waitcnt lgkmcnt(14)
    v_mfma_f32_32x32x16_bf16 a[64:79], a[176:179], v[172:175], a[64:79]
    ds_read_b64_tr_b16 a[144:145], v9 offset:4096
    ds_read_b64_tr_b16 a[146:147], v9 offset:6144
    ds_read_b64_tr_b16 a[148:149], v10 offset:4096
    ds_read_b64_tr_b16 a[150:151], v10 offset:6144
    ds_read_b64_tr_b16 a[152:153], v11 offset:4096
    ds_read_b64_tr_b16 a[154:155], v11 offset:6144
    ds_read_b64_tr_b16 a[156:157], v12 offset:4096
    ds_read_b64_tr_b16 a[158:159], v12 offset:6144
    s_waitcnt lgkmcnt(15)
    v_mfma_f32_32x32x16_bf16 a[80:95], a[180:183], v[172:175], a[80:95]
    v_accvgpr_read_b32 v134, a38
    v_accvgpr_read_b32 v135, a39
    v_fma_f32 v134, v134, s44, -v24
    v_fma_f32 v135, v135, s44, -v24
    v_exp_f32 v132, v132
    v_exp_f32 v133, v133
    v_add_f32 v26, v26, v130
    v_add_f32 v27, v27, v131
    v_cvt_pk_bf16_f32 v128, v128, v129
    v_mfma_f32_32x32x16_bf16 a[96:111], a[184:187], v[172:175], a[96:111]
    v_accvgpr_read_b32 v144, a40
    v_accvgpr_read_b32 v145, a41
    v_fma_f32 v144, v144, s44, -v24
    v_fma_f32 v145, v145, s44, -v24
    v_exp_f32 v134, v134
    v_exp_f32 v135, v135
    v_add_f32 v26, v26, v132
    v_add_f32 v27, v27, v133
    v_mfma_f32_32x32x16_bf16 a[112:127], a[188:191], v[172:175], a[112:127]
    v_cvt_pk_bf16_f32 v129, v130, v131
    v_accvgpr_read_b32 v146, a42
    v_accvgpr_read_b32 v147, a43
    v_fma_f32 v146, v146, s44, -v24
    v_fma_f32 v147, v147, s44, -v24
    v_exp_f32 v144, v144
    v_exp_f32 v145, v145
    v_add_f32 v26, v26, v134
    v_add_f32 v27, v27, v135
    s_waitcnt lgkmcnt(14)
    v_mfma_f32_32x32x16_bf16 a[192:207], a[128:131], v[184:187], 0
    ds_read_b64_tr_b16 a[160:161], v9 offset:8192
    ds_read_b64_tr_b16 a[162:163], v9 offset:10240
    ds_read_b64_tr_b16 a[164:165], v10 offset:8192
    ds_read_b64_tr_b16 a[166:167], v10 offset:10240
    ds_read_b64_tr_b16 a[168:169], v11 offset:8192
    ds_read_b64_tr_b16 a[170:171], v11 offset:10240
    ds_read_b64_tr_b16 a[172:173], v12 offset:8192
    ds_read_b64_tr_b16 a[174:175], v12 offset:10240
    v_cvt_pk_bf16_f32 v130, v132, v133
    v_accvgpr_read_b32 v148, a44
    v_accvgpr_read_b32 v149, a45
    v_fma_f32 v148, v148, s44, -v24
    s_waitcnt lgkmcnt(15)
    v_mfma_f32_32x32x16_bf16 a[208:223], a[132:135], v[184:187], 0
    v_fma_f32 v149, v149, s44, -v24
    v_exp_f32 v146, v146
    v_exp_f32 v147, v147
    v_add_f32 v26, v26, v144
    v_add_f32 v27, v27, v145
    v_cvt_pk_bf16_f32 v131, v134, v135
    v_accvgpr_read_b32 v150, a46
    v_accvgpr_read_b32 v151, a47
    v_fma_f32 v150, v150, s44, -v24
    v_fma_f32 v151, v151, s44, -v24
    v_exp_f32 v148, v148
    v_exp_f32 v149, v149
    v_add_f32 v26, v26, v146
    v_mfma_f32_32x32x16_bf16 a[224:239], a[136:139], v[184:187], 0
    v_add_f32 v27, v27, v147
    v_cvt_pk_bf16_f32 v144, v144, v145
    v_exp_f32 v150, v150
    v_exp_f32 v151, v151
    v_add_f32 v26, v26, v148
    v_add_f32 v27, v27, v149
    v_cvt_pk_bf16_f32 v145, v146, v147
    v_add_f32 v26, v26, v150
    s_lshl_b32 s40, s16, 13
    s_add_u32 s41, s40, 4096
    v_lshlrev_b32 v13, 4, v0
    v_accvgpr_read_b32 v56, a64
    v_mfma_f32_32x32x16_bf16 a[240:255], a[140:143], v[184:187], 0
    v_accvgpr_read_b32 v57, a65
    v_accvgpr_read_b32 v58, a66
    v_accvgpr_read_b32 v59, a67
    v_accvgpr_read_b32 v60, a68
    v_accvgpr_read_b32 v61, a69
    v_accvgpr_read_b32 v62, a70
    v_accvgpr_read_b32 v63, a71
    v_accvgpr_read_b32 v72, a72
    v_accvgpr_read_b32 v73, a73
    v_accvgpr_read_b32 v74, a74
    v_accvgpr_read_b32 v75, a75
    v_accvgpr_read_b32 v76, a76
    v_accvgpr_read_b32 v77, a77
    s_waitcnt lgkmcnt(14)
    v_mfma_f32_32x32x16_bf16 a[192:207], a[144:147], v[188:191], a[192:207]
    ds_read_b64_tr_b16 a[176:177], v9 offset:12288
    ds_read_b64_tr_b16 a[178:179], v9 offset:14336
    ds_read_b64_tr_b16 a[180:181], v10 offset:12288
    ds_read_b64_tr_b16 a[182:183], v10 offset:14336
    ds_read_b64_tr_b16 a[184:185], v11 offset:12288
    ds_read_b64_tr_b16 a[186:187], v11 offset:14336
    ds_read_b64_tr_b16 a[188:189], v12 offset:12288
    ds_read_b64_tr_b16 a[190:191], v12 offset:14336
    v_add_f32 v27, v27, v151
    v_cvt_pk_bf16_f32 v146, v148, v149
    v_cvt_pk_bf16_f32 v147, v150, v151
    v_accvgpr_read_b32 v160, a48
    s_waitcnt lgkmcnt(15)
    v_mfma_f32_32x32x16_bf16 a[208:223], a[148:151], v[188:191], a[208:223]
    v_accvgpr_read_b32 v161, a49
    v_fma_f32 v160, v160, s44, -v24
    v_fma_f32 v161, v161, s44, -v24
    v_accvgpr_read_b32 v162, a50
    v_accvgpr_read_b32 v163, a51
    v_fma_f32 v162, v162, s44, -v24
    v_fma_f32 v163, v163, s44, -v24
    v_exp_f32 v160, v160
    v_exp_f32 v161, v161
    v_accvgpr_read_b32 v164, a52
    v_accvgpr_read_b32 v165, a53
    v_fma_f32 v164, v164, s44, -v24
    v_fma_f32 v165, v165, s44, -v24
    v_mfma_f32_32x32x16_bf16 a[224:239], a[152:155], v[188:191], a[224:239]
    v_exp_f32 v162, v162
    v_exp_f32 v163, v163
    v_add_f32 v26, v26, v160
    v_add_f32 v27, v27, v161
    v_accvgpr_read_b32 v166, a54
    v_accvgpr_read_b32 v167, a55
    v_fma_f32 v166, v166, s44, -v24
    v_fma_f32 v167, v167, s44, -v24
    v_exp_f32 v164, v164
    v_accvgpr_read_b32 v78, a78
    v_accvgpr_read_b32 v79, a79
    v_accvgpr_read_b32 v88, a80
    v_accvgpr_read_b32 v89, a81
    v_mfma_f32_32x32x16_bf16 a[240:255], a[156:159], v[188:191], a[240:255]
    v_accvgpr_read_b32 v90, a82
    v_accvgpr_read_b32 v91, a83
    v_accvgpr_read_b32 v92, a84
    v_accvgpr_read_b32 v93, a85
    v_accvgpr_read_b32 v94, a86
    v_accvgpr_read_b32 v95, a87
    v_accvgpr_read_b32 v104, a88
    v_accvgpr_read_b32 v105, a89
    v_accvgpr_read_b32 v106, a90
    v_accvgpr_read_b32 v107, a91
    v_accvgpr_read_b32 v108, a92
    v_accvgpr_read_b32 v109, a93
    v_accvgpr_read_b32 v110, a94
    s_barrier
    v_add_u32 v9, 0x4000, v9
    v_add_u32 v10, 0x4000, v10
    v_add_u32 v11, 0x4000, v11
    v_add_u32 v12, 0x4000, v12
    s_waitcnt lgkmcnt(14)
    v_mfma_f32_32x32x16_bf16 a[192:207], a[160:163], v[200:203], a[192:207]
    ds_read_b64_tr_b16 a[128:129], v9 offset:0
    ds_read_b64_tr_b16 a[130:131], v9 offset:2048
    ds_read_b64_tr_b16 a[132:133], v10 offset:0
    ds_read_b64_tr_b16 a[134:135], v10 offset:2048
    ds_read_b64_tr_b16 a[136:137], v11 offset:0
    ds_read_b64_tr_b16 a[138:139], v11 offset:2048
    ds_read_b64_tr_b16 a[140:141], v12 offset:0
    ds_read_b64_tr_b16 a[142:143], v12 offset:2048
    v_exp_f32 v165, v165
    v_add_f32 v26, v26, v162
    v_add_f32 v27, v27, v163
    v_cvt_pk_bf16_f32 v160, v160, v161
    s_waitcnt lgkmcnt(15)
    v_mfma_f32_32x32x16_bf16 a[208:223], a[164:167], v[200:203], a[208:223]
    v_accvgpr_read_b32 v176, a56
    v_accvgpr_read_b32 v177, a57
    v_fma_f32 v176, v176, s44, -v24
    v_fma_f32 v177, v177, s44, -v24
    v_exp_f32 v166, v166
    v_exp_f32 v167, v167
    v_add_f32 v26, v26, v164
    v_add_f32 v27, v27, v165
    v_cvt_pk_bf16_f32 v161, v162, v163
    v_accvgpr_read_b32 v178, a58
    v_accvgpr_read_b32 v179, a59
    v_fma_f32 v178, v178, s44, -v24
    v_fma_f32 v179, v179, s44, -v24
    v_mfma_f32_32x32x16_bf16 a[224:239], a[168:171], v[200:203], a[224:239]
    v_exp_f32 v176, v176
    v_exp_f32 v177, v177
    v_add_f32 v26, v26, v166
    v_add_f32 v27, v27, v167
    v_cvt_pk_bf16_f32 v162, v164, v165
    v_accvgpr_read_b32 v180, a60
    v_accvgpr_read_b32 v181, a61
    v_fma_f32 v180, v180, s44, -v24
    v_fma_f32 v181, v181, s44, -v24
    v_accvgpr_read_b32 v111, a95
    v_accvgpr_read_b32 v120, a96
    v_accvgpr_read_b32 v121, a97
    v_accvgpr_read_b32 v122, a98
    v_mfma_f32_32x32x16_bf16 a[240:255], a[172:175], v[200:203], a[240:255]
    v_accvgpr_read_b32 v123, a99
    v_accvgpr_read_b32 v124, a100
    v_accvgpr_read_b32 v125, a101
    v_accvgpr_read_b32 v126, a102
    v_accvgpr_read_b32 v127, a103
    v_accvgpr_read_b32 v136, a104
    v_accvgpr_read_b32 v137, a105
    v_accvgpr_read_b32 v138, a106
    v_accvgpr_read_b32 v139, a107
    v_accvgpr_read_b32 v140, a108
    v_accvgpr_read_b32 v141, a109
    v_accvgpr_read_b32 v142, a110
    v_accvgpr_read_b32 v143, a111
    s_waitcnt lgkmcnt(14)
    v_mfma_f32_32x32x16_bf16 a[192:207], a[176:179], v[204:207], a[192:207]
    ds_read_b64_tr_b16 a[144:145], v9 offset:4096
    ds_read_b64_tr_b16 a[146:147], v9 offset:6144
    ds_read_b64_tr_b16 a[148:149], v10 offset:4096
    ds_read_b64_tr_b16 a[150:151], v10 offset:6144
    ds_read_b64_tr_b16 a[152:153], v11 offset:4096
    ds_read_b64_tr_b16 a[154:155], v11 offset:6144
    ds_read_b64_tr_b16 a[156:157], v12 offset:4096
    ds_read_b64_tr_b16 a[158:159], v12 offset:6144
    v_exp_f32 v178, v178
    v_exp_f32 v179, v179
    v_add_f32 v26, v26, v176
    v_add_f32 v27, v27, v177
    s_waitcnt lgkmcnt(15)
    v_mfma_f32_32x32x16_bf16 a[208:223], a[180:183], v[204:207], a[208:223]
    v_cvt_pk_bf16_f32 v163, v166, v167
    v_accvgpr_read_b32 v182, a62
    v_accvgpr_read_b32 v183, a63
    v_fma_f32 v182, v182, s44, -v24
    v_fma_f32 v183, v183, s44, -v24
    v_exp_f32 v180, v180
    v_exp_f32 v181, v181
    v_add_f32 v26, v26, v178
    v_add_f32 v27, v27, v179
    v_cvt_pk_bf16_f32 v176, v176, v177
    v_exp_f32 v182, v182
    v_exp_f32 v183, v183
    v_mfma_f32_32x32x16_bf16 a[224:239], a[184:187], v[204:207], a[224:239]
    v_add_f32 v26, v26, v180
    v_add_f32 v27, v27, v181
    v_cvt_pk_bf16_f32 v177, v178, v179
    v_add_f32 v26, v26, v182
    v_add_f32 v27, v27, v183
    v_cvt_pk_bf16_f32 v178, v180, v181
    v_cvt_pk_bf16_f32 v179, v182, v183
    v_accvgpr_read_b32 v152, a112
    v_accvgpr_read_b32 v153, a113
    v_accvgpr_read_b32 v154, a114
    v_accvgpr_read_b32 v155, a115
    v_accvgpr_read_b32 v156, a116
    v_mfma_f32_32x32x16_bf16 a[240:255], a[188:191], v[204:207], a[240:255]
    v_accvgpr_read_b32 v157, a117
    v_accvgpr_read_b32 v158, a118
    v_accvgpr_read_b32 v159, a119
    v_accvgpr_read_b32 v168, a120
    v_accvgpr_read_b32 v169, a121
    v_accvgpr_read_b32 v170, a122
    v_accvgpr_read_b32 v171, a123
    v_accvgpr_read_b32 v172, a124
    v_accvgpr_read_b32 v173, a125
    v_accvgpr_read_b32 v174, a126
    v_accvgpr_read_b32 v175, a127
    v_and_b32 v6, 1, v0
    s_waitcnt lgkmcnt(14)
    v_mfma_f32_32x32x16_bf16 a[192:207], a[128:131], v[216:219], a[192:207]
    ds_read_b64_tr_b16 a[160:161], v9 offset:8192
    ds_read_b64_tr_b16 a[162:163], v9 offset:10240
    ds_read_b64_tr_b16 a[164:165], v10 offset:8192
    ds_read_b64_tr_b16 a[166:167], v10 offset:10240
    ds_read_b64_tr_b16 a[168:169], v11 offset:8192
    ds_read_b64_tr_b16 a[170:171], v11 offset:10240
    s_waitcnt lgkmcnt(15)
    v_mfma_f32_32x32x16_bf16 a[208:223], a[132:135], v[216:219], a[208:223]
    ds_read_b64_tr_b16 a[172:173], v12 offset:8192
    ds_read_b64_tr_b16 a[174:175], v12 offset:10240
    v_bfe_u32 v7, v0, 1, 1
    v_bfe_u32 v8, v0, 2, 2
    v_bfe_u32 v5, v0, 4, 1
    v_lshl_or_b32 v5, v5, 1, v6
    v_mfma_f32_32x32x16_bf16 a[224:239], a[136:139], v[216:219], a[224:239]
    v_lshlrev_b32 v5, 4, v5
    v_lshl_add_u32 v5, v7, 3, v5
    v_lshrrev_b32 v4, 5, v0
    v_lshl_add_u32 v4, v4, 3, v8
    v_mul_u32_u24 v4, 320, v4
    v_add_u32 v1, v4, v5
    s_waitcnt lgkmcnt(15)
    v_mfma_f32_32x32x16_bf16 a[240:255], a[140:143], v[216:219], a[240:255]
    v_add_u32 v2, 61440, v1
    v_add_u32 v3, 122880, v1
    v_add_u32 v4, s40, v13
    s_and_b32 s42, s14, 28
    s_lshl_b32 s43, s15, 5
    s_add_u32 s42, s42, s43
    s_mul_i32 s42, s42, 24576
    s_waitcnt lgkmcnt(14)
    v_mfma_f32_32x32x16_bf16 a[192:207], a[144:147], v[220:223], a[192:207]
    ds_read_b64_tr_b16 a[176:177], v9 offset:12288
    ds_read_b64_tr_b16 a[178:179], v9 offset:14336
    ds_read_b64_tr_b16 a[180:181], v10 offset:12288
    ds_read_b64_tr_b16 a[182:183], v10 offset:14336
    ds_read_b64_tr_b16 a[184:185], v11 offset:12288
    ds_read_b64_tr_b16 a[186:187], v11 offset:14336
    s_waitcnt lgkmcnt(15)
    v_mfma_f32_32x32x16_bf16 a[208:223], a[148:151], v[220:223], a[208:223]
    ds_read_b64_tr_b16 a[188:189], v12 offset:12288
    ds_read_b64_tr_b16 a[190:191], v12 offset:14336
    s_add_u32 s4, s98, s42
    s_addc_u32 s5, s99, 0
    s_mov_b32 s24, s4
    s_and_b32 s25, s5, 0xffff
    v_mfma_f32_32x32x16_bf16 a[224:239], a[152:155], v[220:223], a[224:239]
    s_mov_b32 s26, 0x18000
    s_mov_b32 s27, 0x00020000
    s_and_b32 s42, s14, 3
    s_lshl_b32 s43, s15, 2
    s_add_u32 s42, s42, s43
    s_mul_i32 s42, s42, 245760
    s_waitcnt lgkmcnt(15)
    v_mfma_f32_32x32x16_bf16 a[240:255], a[156:159], v[220:223], a[240:255]
    s_add_u32 s42, s42, 0x2000000
    s_add_u32 s6, s98, s42
    s_addc_u32 s7, s99, 0
    s_mov_b32 s28, s6
    s_and_b32 s29, s7, 0xffff
    s_mov_b32 s30, 0x3c000
    s_mov_b32 s31, 0x00020000
    s_barrier
    v_add_u32 v9, 0x4000, v9
    v_add_u32 v10, 0x4000, v10
    v_add_u32 v11, 0x4000, v11
    v_add_u32 v12, 0x4000, v12
    s_waitcnt lgkmcnt(14)
    v_mfma_f32_32x32x16_bf16 a[192:207], a[160:163], v[232:235], a[192:207]
    ds_read_b64_tr_b16 a[128:129], v9 offset:0
    ds_read_b64_tr_b16 a[130:131], v9 offset:2048
    ds_read_b64_tr_b16 a[132:133], v10 offset:0
    ds_read_b64_tr_b16 a[134:135], v10 offset:2048
    s_waitcnt lgkmcnt(15)
    v_mfma_f32_32x32x16_bf16 a[208:223], a[164:167], v[232:235], a[208:223]
    ds_read_b64_tr_b16 a[136:137], v11 offset:0
    ds_read_b64_tr_b16 a[138:139], v11 offset:2048
    ds_read_b64_tr_b16 a[140:141], v12 offset:0
    ds_read_b64_tr_b16 a[142:143], v12 offset:2048
    v_add_f32 v250, v250, v251
    s_waitcnt lgkmcnt(15)
    v_mfma_f32_32x32x16_bf16 a[224:239], a[168:171], v[232:235], a[224:239]
    v_add_f32 v26, v26, v27
    v_fma_f32 v250, v250, v16, v26
    v_mov_b32 v18, v250
    v_mov_b32 v19, v250
    s_nop 1
    v_permlane32_swap_b32 v18, v19
    v_mfma_f32_32x32x16_bf16 a[240:255], a[172:175], v[232:235], a[240:255]
    v_add_f32 v250, v18, v19
    v_rcp_f32 v26, v250
    s_nop 0
    v_mul_f32 v16, v16, v26
    v_mov_b32 v27, v26
    v_mov_b32 v250, v16
    s_waitcnt lgkmcnt(14)
    v_mfma_f32_32x32x16_bf16 a[192:207], a[176:179], v[236:239], a[192:207]
    ds_read_b64_tr_b16 a[144:145], v9 offset:4096
    ds_read_b64_tr_b16 a[146:147], v9 offset:6144
    ds_read_b64_tr_b16 a[148:149], v10 offset:4096
    ds_read_b64_tr_b16 a[150:151], v10 offset:6144
    s_waitcnt lgkmcnt(15)
    v_mfma_f32_32x32x16_bf16 a[208:223], a[180:183], v[236:239], a[208:223]
    ds_read_b64_tr_b16 a[152:153], v11 offset:4096
    ds_read_b64_tr_b16 a[154:155], v11 offset:6144
    ds_read_b64_tr_b16 a[156:157], v12 offset:4096
    ds_read_b64_tr_b16 a[158:159], v12 offset:6144
    v_mov_b32 v251, v16
    s_waitcnt lgkmcnt(15)
    v_mfma_f32_32x32x16_bf16 a[224:239], a[184:187], v[236:239], a[224:239]
    v_pk_mul_f32 v[56:57], v[56:57], v[250:251]
    v_pk_mul_f32 v[58:59], v[58:59], v[250:251]
    v_pk_mul_f32 v[60:61], v[60:61], v[250:251]
    v_pk_mul_f32 v[62:63], v[62:63], v[250:251]
    v_pk_mul_f32 v[72:73], v[72:73], v[250:251]
    v_mfma_f32_32x32x16_bf16 a[240:255], a[188:191], v[236:239], a[240:255]
    v_pk_mul_f32 v[74:75], v[74:75], v[250:251]
    v_pk_mul_f32 v[76:77], v[76:77], v[250:251]
    v_pk_mul_f32 v[78:79], v[78:79], v[250:251]
    v_pk_mul_f32 v[88:89], v[88:89], v[250:251]
    v_pk_mul_f32 v[90:91], v[90:91], v[250:251]
    s_waitcnt lgkmcnt(14)
    v_mfma_f32_32x32x16_bf16 a[192:207], a[128:131], v[64:67], a[192:207]
    ds_read_b64_tr_b16 a[160:161], v9 offset:8192
    ds_read_b64_tr_b16 a[162:163], v9 offset:10240
    ds_read_b64_tr_b16 a[164:165], v10 offset:8192
    ds_read_b64_tr_b16 a[166:167], v10 offset:10240
    s_waitcnt lgkmcnt(15)
    v_mfma_f32_32x32x16_bf16 a[208:223], a[132:135], v[64:67], a[208:223]
    ds_read_b64_tr_b16 a[168:169], v11 offset:8192
    ds_read_b64_tr_b16 a[170:171], v11 offset:10240
    ds_read_b64_tr_b16 a[172:173], v12 offset:8192
    ds_read_b64_tr_b16 a[174:175], v12 offset:10240
    v_pk_mul_f32 v[92:93], v[92:93], v[250:251]
    s_waitcnt lgkmcnt(15)
    v_mfma_f32_32x32x16_bf16 a[224:239], a[136:139], v[64:67], a[224:239]
    v_pk_mul_f32 v[94:95], v[94:95], v[250:251]
    v_pk_mul_f32 v[104:105], v[104:105], v[250:251]
    v_pk_mul_f32 v[106:107], v[106:107], v[250:251]
    v_pk_mul_f32 v[108:109], v[108:109], v[250:251]
    v_pk_mul_f32 v[110:111], v[110:111], v[250:251]
    v_mfma_f32_32x32x16_bf16 a[240:255], a[140:143], v[64:67], a[240:255]
    v_pk_mul_f32 v[120:121], v[120:121], v[250:251]
    v_pk_mul_f32 v[122:123], v[122:123], v[250:251]
    v_pk_mul_f32 v[124:125], v[124:125], v[250:251]
    v_pk_mul_f32 v[126:127], v[126:127], v[250:251]
    v_pk_mul_f32 v[136:137], v[136:137], v[250:251]
    s_waitcnt lgkmcnt(14)
    v_mfma_f32_32x32x16_bf16 a[192:207], a[144:147], v[80:83], a[192:207]
    ds_read_b64_tr_b16 a[176:177], v9 offset:12288
    ds_read_b64_tr_b16 a[178:179], v9 offset:14336
    ds_read_b64_tr_b16 a[180:181], v10 offset:12288
    ds_read_b64_tr_b16 a[182:183], v10 offset:14336
    s_waitcnt lgkmcnt(15)
    v_mfma_f32_32x32x16_bf16 a[208:223], a[148:151], v[80:83], a[208:223]
    ds_read_b64_tr_b16 a[184:185], v11 offset:12288
    ds_read_b64_tr_b16 a[186:187], v11 offset:14336
    ds_read_b64_tr_b16 a[188:189], v12 offset:12288
    ds_read_b64_tr_b16 a[190:191], v12 offset:14336
    v_pk_mul_f32 v[138:139], v[138:139], v[250:251]
    s_waitcnt lgkmcnt(15)
    v_mfma_f32_32x32x16_bf16 a[224:239], a[152:155], v[80:83], a[224:239]
    v_pk_mul_f32 v[140:141], v[140:141], v[250:251]
    v_pk_mul_f32 v[142:143], v[142:143], v[250:251]
    v_pk_mul_f32 v[152:153], v[152:153], v[250:251]
    v_pk_mul_f32 v[154:155], v[154:155], v[250:251]
    v_pk_mul_f32 v[156:157], v[156:157], v[250:251]
    v_mfma_f32_32x32x16_bf16 a[240:255], a[156:159], v[80:83], a[240:255]
    v_pk_mul_f32 v[158:159], v[158:159], v[250:251]
    v_pk_mul_f32 v[168:169], v[168:169], v[250:251]
    v_pk_mul_f32 v[170:171], v[170:171], v[250:251]
    v_pk_mul_f32 v[172:173], v[172:173], v[250:251]
    v_pk_mul_f32 v[174:175], v[174:175], v[250:251]
    s_barrier
    v_add_u32 v9, 0x4000, v9
    v_add_u32 v10, 0x4000, v10
    v_add_u32 v11, 0x4000, v11
    v_add_u32 v12, 0x4000, v12
    s_waitcnt lgkmcnt(14)
    v_mfma_f32_32x32x16_bf16 a[192:207], a[160:163], v[96:99], a[192:207]
    ds_read_b64_tr_b16 a[128:129], v9 offset:0
    ds_read_b64_tr_b16 a[130:131], v9 offset:2048
    s_waitcnt lgkmcnt(14)
    v_mfma_f32_32x32x16_bf16 a[208:223], a[164:167], v[96:99], a[208:223]
    ds_read_b64_tr_b16 a[132:133], v10 offset:0
    ds_read_b64_tr_b16 a[134:135], v10 offset:2048
    s_waitcnt lgkmcnt(14)
    v_mfma_f32_32x32x16_bf16 a[224:239], a[168:171], v[96:99], a[224:239]
    ds_read_b64_tr_b16 a[136:137], v11 offset:0
    ds_read_b64_tr_b16 a[138:139], v11 offset:2048
    s_waitcnt lgkmcnt(14)
    v_mfma_f32_32x32x16_bf16 a[240:255], a[172:175], v[96:99], a[240:255]
    ds_read_b64_tr_b16 a[140:141], v12 offset:0
    ds_read_b64_tr_b16 a[142:143], v12 offset:2048
    s_waitcnt lgkmcnt(14)
    v_mfma_f32_32x32x16_bf16 a[192:207], a[176:179], v[112:115], a[192:207]
    ds_read_b64_tr_b16 a[144:145], v9 offset:4096
    ds_read_b64_tr_b16 a[146:147], v9 offset:6144
    s_waitcnt lgkmcnt(14)
    v_mfma_f32_32x32x16_bf16 a[208:223], a[180:183], v[112:115], a[208:223]
    ds_read_b64_tr_b16 a[148:149], v10 offset:4096
    ds_read_b64_tr_b16 a[150:151], v10 offset:6144
    s_waitcnt lgkmcnt(14)
    v_mfma_f32_32x32x16_bf16 a[224:239], a[184:187], v[112:115], a[224:239]
    ds_read_b64_tr_b16 a[152:153], v11 offset:4096
    ds_read_b64_tr_b16 a[154:155], v11 offset:6144
    s_waitcnt lgkmcnt(14)
    v_mfma_f32_32x32x16_bf16 a[240:255], a[188:191], v[112:115], a[240:255]
    ds_read_b64_tr_b16 a[156:157], v12 offset:4096
    ds_read_b64_tr_b16 a[158:159], v12 offset:6144
    ds_read_b64_tr_b16 a[160:161], v9 offset:8192
    ds_read_b64_tr_b16 a[162:163], v9 offset:10240
    ds_read_b64_tr_b16 a[176:177], v9 offset:12288
    ds_read_b64_tr_b16 a[178:179], v9 offset:14336
    ds_read_b64_tr_b16 a[164:165], v10 offset:8192
    ds_read_b64_tr_b16 a[166:167], v10 offset:10240
    ds_read_b64_tr_b16 a[180:181], v10 offset:12288
    ds_read_b64_tr_b16 a[182:183], v10 offset:14336
    ds_read_b64_tr_b16 a[168:169], v11 offset:8192
    ds_read_b64_tr_b16 a[170:171], v11 offset:10240
    ds_read_b64_tr_b16 a[184:185], v11 offset:12288
    ds_read_b64_tr_b16 a[186:187], v11 offset:14336
    ds_read_b64_tr_b16 a[172:173], v12 offset:8192
    ds_read_b64_tr_b16 a[174:175], v12 offset:10240
    ds_read_b64_tr_b16 a[188:189], v12 offset:12288
    ds_read_b64_tr_b16 a[190:191], v12 offset:14336
    s_waitcnt lgkmcnt(15)
    v_mfma_f32_32x32x16_bf16 a[192:207], a[128:131], v[128:131], a[192:207]
    v_mfma_f32_32x32x16_bf16 a[192:207], a[144:147], v[144:147], a[192:207]
    s_waitcnt lgkmcnt(14)
    v_mfma_f32_32x32x16_bf16 a[192:207], a[160:163], v[160:163], a[192:207]
    s_waitcnt lgkmcnt(12)
    v_mfma_f32_32x32x16_bf16 a[192:207], a[176:179], v[176:179], a[192:207]
    v_mfma_f32_32x32x16_bf16 a[208:223], a[132:135], v[128:131], a[208:223]
    v_mfma_f32_32x32x16_bf16 a[208:223], a[148:151], v[144:147], a[208:223]
    s_nop 9
    v_accvgpr_read_b32 v216, a192
    v_accvgpr_read_b32 v217, a193
    v_accvgpr_read_b32 v218, a194
    v_accvgpr_read_b32 v219, a195
    v_accvgpr_read_b32 v220, a196
    v_accvgpr_read_b32 v221, a197
    v_accvgpr_read_b32 v222, a198
    v_accvgpr_read_b32 v223, a199
    v_pk_fma_f32 v[56:57], v[216:217], v[26:27], v[56:57]
    v_pk_fma_f32 v[58:59], v[218:219], v[26:27], v[58:59]
    v_pk_fma_f32 v[60:61], v[220:221], v[26:27], v[60:61]
    s_waitcnt lgkmcnt(10)
    v_mfma_f32_32x32x16_bf16 a[208:223], a[164:167], v[160:163], a[208:223]
    v_pk_fma_f32 v[62:63], v[222:223], v[26:27], v[62:63]
    v_cvt_pk_bf16_f32 v184, v56, v57
    v_cvt_pk_bf16_f32 v185, v58, v59
    v_cvt_pk_bf16_f32 v186, v60, v61
    v_cvt_pk_bf16_f32 v187, v62, v63
    buffer_store_dwordx4 v[184:187], v13, s[36:39], s40 offen offset:0 sc1
    v_accvgpr_read_b32 v224, a200
    v_accvgpr_read_b32 v225, a201
    v_accvgpr_read_b32 v226, a202
    v_accvgpr_read_b32 v227, a203
    v_accvgpr_read_b32 v228, a204
    s_waitcnt lgkmcnt(8)
    v_mfma_f32_32x32x16_bf16 a[208:223], a[180:183], v[176:179], a[208:223]
    v_accvgpr_read_b32 v229, a205
    v_accvgpr_read_b32 v230, a206
    v_accvgpr_read_b32 v231, a207
    v_pk_fma_f32 v[72:73], v[224:225], v[26:27], v[72:73]
    v_pk_fma_f32 v[74:75], v[226:227], v[26:27], v[74:75]
    v_pk_fma_f32 v[76:77], v[228:229], v[26:27], v[76:77]
    v_pk_fma_f32 v[78:79], v[230:231], v[26:27], v[78:79]
    v_cvt_pk_bf16_f32 v188, v72, v73
    v_cvt_pk_bf16_f32 v189, v74, v75
    v_cvt_pk_bf16_f32 v190, v76, v77
    v_cvt_pk_bf16_f32 v191, v78, v79
    buffer_store_dwordx4 v[188:191], v13, s[36:39], s40 offen offset:1024 sc1
    v_mfma_f32_32x32x16_bf16 a[224:239], a[136:139], v[128:131], a[224:239]
    v_mfma_f32_32x32x16_bf16 a[224:239], a[152:155], v[144:147], a[224:239]
    v_accvgpr_read_b32 v232, a208
    v_accvgpr_read_b32 v233, a209
    v_accvgpr_read_b32 v234, a210
    v_accvgpr_read_b32 v235, a211
    v_accvgpr_read_b32 v236, a212
    v_accvgpr_read_b32 v237, a213
    v_accvgpr_read_b32 v238, a214
    v_accvgpr_read_b32 v239, a215
    v_pk_fma_f32 v[88:89], v[232:233], v[26:27], v[88:89]
    v_pk_fma_f32 v[90:91], v[234:235], v[26:27], v[90:91]
    v_pk_fma_f32 v[92:93], v[236:237], v[26:27], v[92:93]
    s_waitcnt lgkmcnt(6)
    v_mfma_f32_32x32x16_bf16 a[224:239], a[168:171], v[160:163], a[224:239]
    v_pk_fma_f32 v[94:95], v[238:239], v[26:27], v[94:95]
    v_cvt_pk_bf16_f32 v192, v88, v89
    v_cvt_pk_bf16_f32 v193, v90, v91
    v_cvt_pk_bf16_f32 v194, v92, v93
    v_cvt_pk_bf16_f32 v195, v94, v95
    buffer_store_dwordx4 v[192:195], v13, s[36:39], s40 offen offset:2048 sc1
    v_accvgpr_read_b32 v240, a216
    v_accvgpr_read_b32 v241, a217
    v_accvgpr_read_b32 v242, a218
    v_accvgpr_read_b32 v243, a219
    v_accvgpr_read_b32 v244, a220
    s_waitcnt lgkmcnt(4)
    v_mfma_f32_32x32x16_bf16 a[224:239], a[184:187], v[176:179], a[224:239]
    v_accvgpr_read_b32 v245, a221
    v_accvgpr_read_b32 v246, a222
    v_accvgpr_read_b32 v247, a223
    v_pk_fma_f32 v[104:105], v[240:241], v[26:27], v[104:105]
    v_pk_fma_f32 v[106:107], v[242:243], v[26:27], v[106:107]
    v_pk_fma_f32 v[108:109], v[244:245], v[26:27], v[108:109]
    v_pk_fma_f32 v[110:111], v[246:247], v[26:27], v[110:111]
    v_cvt_pk_bf16_f32 v196, v104, v105
    v_cvt_pk_bf16_f32 v197, v106, v107
    v_cvt_pk_bf16_f32 v198, v108, v109
    v_cvt_pk_bf16_f32 v199, v110, v111
    buffer_store_dwordx4 v[196:199], v13, s[36:39], s40 offen offset:3072 sc1
    v_mfma_f32_32x32x16_bf16 a[240:255], a[140:143], v[128:131], a[240:255]
    v_mfma_f32_32x32x16_bf16 a[240:255], a[156:159], v[144:147], a[240:255]
    v_accvgpr_read_b32 v216, a224
    v_accvgpr_read_b32 v217, a225
    v_accvgpr_read_b32 v218, a226
    v_accvgpr_read_b32 v219, a227
    v_accvgpr_read_b32 v220, a228
    v_accvgpr_read_b32 v221, a229
    v_accvgpr_read_b32 v222, a230
    v_accvgpr_read_b32 v223, a231
    v_pk_fma_f32 v[120:121], v[216:217], v[26:27], v[120:121]
    v_pk_fma_f32 v[122:123], v[218:219], v[26:27], v[122:123]
    v_pk_fma_f32 v[124:125], v[220:221], v[26:27], v[124:125]
    s_waitcnt lgkmcnt(2)
    v_mfma_f32_32x32x16_bf16 a[240:255], a[172:175], v[160:163], a[240:255]
    v_pk_fma_f32 v[126:127], v[222:223], v[26:27], v[126:127]
    v_cvt_pk_bf16_f32 v200, v120, v121
    v_cvt_pk_bf16_f32 v201, v122, v123
    v_cvt_pk_bf16_f32 v202, v124, v125
    v_cvt_pk_bf16_f32 v203, v126, v127
    buffer_store_dwordx4 v[200:203], v13, s[36:39], s41 offen offset:0 sc1
    v_accvgpr_read_b32 v224, a232
    v_accvgpr_read_b32 v225, a233
    v_accvgpr_read_b32 v226, a234
    v_accvgpr_read_b32 v227, a235
    v_accvgpr_read_b32 v228, a236
    s_waitcnt lgkmcnt(0)
    v_mfma_f32_32x32x16_bf16 a[240:255], a[188:191], v[176:179], a[240:255]
    v_accvgpr_read_b32 v229, a237
    v_accvgpr_read_b32 v230, a238
    v_accvgpr_read_b32 v231, a239
    v_pk_fma_f32 v[136:137], v[224:225], v[26:27], v[136:137]
    v_pk_fma_f32 v[138:139], v[226:227], v[26:27], v[138:139]
    v_pk_fma_f32 v[140:141], v[228:229], v[26:27], v[140:141]
    v_pk_fma_f32 v[142:143], v[230:231], v[26:27], v[142:143]
    v_cvt_pk_bf16_f32 v204, v136, v137
    v_cvt_pk_bf16_f32 v205, v138, v139
    v_cvt_pk_bf16_f32 v206, v140, v141
    v_cvt_pk_bf16_f32 v207, v142, v143
    buffer_store_dwordx4 v[204:207], v13, s[36:39], s41 offen offset:1024 sc1
    v_accvgpr_read_b32 v232, a240
    v_accvgpr_read_b32 v233, a241
    v_accvgpr_read_b32 v234, a242
    v_accvgpr_read_b32 v235, a243
    v_accvgpr_read_b32 v236, a244
    v_accvgpr_read_b32 v237, a245
    v_accvgpr_read_b32 v238, a246
    v_accvgpr_read_b32 v239, a247
    v_pk_fma_f32 v[152:153], v[232:233], v[26:27], v[152:153]
    v_pk_fma_f32 v[154:155], v[234:235], v[26:27], v[154:155]
    v_pk_fma_f32 v[156:157], v[236:237], v[26:27], v[156:157]
    v_pk_fma_f32 v[158:159], v[238:239], v[26:27], v[158:159]
    v_cvt_pk_bf16_f32 v208, v152, v153
    v_cvt_pk_bf16_f32 v209, v154, v155
    v_cvt_pk_bf16_f32 v210, v156, v157
    v_cvt_pk_bf16_f32 v211, v158, v159
    buffer_store_dwordx4 v[208:211], v13, s[36:39], s41 offen offset:2048 sc1
    v_accvgpr_read_b32 v240, a248
    v_accvgpr_read_b32 v241, a249
    v_accvgpr_read_b32 v242, a250
    v_accvgpr_read_b32 v243, a251
    v_accvgpr_read_b32 v244, a252
    v_accvgpr_read_b32 v245, a253
    v_accvgpr_read_b32 v246, a254
    v_accvgpr_read_b32 v247, a255
    v_pk_fma_f32 v[168:169], v[240:241], v[26:27], v[168:169]
    v_pk_fma_f32 v[170:171], v[242:243], v[26:27], v[170:171]
    v_pk_fma_f32 v[172:173], v[244:245], v[26:27], v[172:173]
    v_pk_fma_f32 v[174:175], v[246:247], v[26:27], v[174:175]
    v_cvt_pk_bf16_f32 v212, v168, v169
    v_cvt_pk_bf16_f32 v213, v170, v171
    v_cvt_pk_bf16_f32 v214, v172, v173
    v_cvt_pk_bf16_f32 v215, v174, v175
    buffer_store_dwordx4 v[212:215], v13, s[36:39], s41 offen offset:3072 sc1
    s_barrier
    s_and_b32 s46, s2, 7
    s_mul_i32 s46, s46, 30720
    s_mul_i32 s47, s16, 10240
    s_add_u32 s46, s46, s47
    s_add_u32 s47, s46, 4096
    s_add_u32 s40, s46, 8192
    ds_read_b64_tr_b16 a[128:129], v2 offset:40960
    ds_read_b64_tr_b16 a[130:131], v2 offset:42240
    ds_read_b64_tr_b16 a[132:133], v2 offset:41024
    ds_read_b64_tr_b16 a[134:135], v2 offset:42304
    ds_read_b64_tr_b16 a[136:137], v2 offset:41088
    ds_read_b64_tr_b16 a[138:139], v2 offset:42368
    ds_read_b64_tr_b16 a[140:141], v2 offset:41152
    ds_read_b64_tr_b16 a[142:143], v2 offset:42432
    ds_read_b64_tr_b16 a[144:145], v2 offset:41216
    ds_read_b64_tr_b16 a[146:147], v2 offset:42496
    ds_read_b64_tr_b16 a[148:149], v2 offset:46080
    ds_read_b64_tr_b16 a[150:151], v2 offset:47360
    s_waitcnt lgkmcnt(10)
    v_mfma_f32_32x32x16_bf16 v[24:39], a[128:131], v[184:187], 0
    ds_read_b64_tr_b16 a[152:153], v2 offset:46144
    ds_read_b64_tr_b16 a[154:155], v2 offset:47424
    s_waitcnt lgkmcnt(10)
    v_mfma_f32_32x32x16_bf16 v[40:55], a[132:135], v[184:187], 0
    ds_read_b64_tr_b16 a[156:157], v2 offset:46208
    ds_read_b64_tr_b16 a[158:159], v2 offset:47488
    s_waitcnt lgkmcnt(10)
    v_mfma_f32_32x32x16_bf16 v[152:167], a[136:139], v[184:187], 0
    ds_read_b64_tr_b16 a[160:161], v2 offset:46272
    ds_read_b64_tr_b16 a[162:163], v2 offset:47552
    s_waitcnt lgkmcnt(10)
    v_mfma_f32_32x32x16_bf16 v[168:183], a[140:143], v[184:187], 0
    ds_read_b64_tr_b16 a[164:165], v2 offset:46336
    ds_read_b64_tr_b16 a[166:167], v2 offset:47616
    s_waitcnt lgkmcnt(10)
    v_mfma_f32_32x32x16_bf16 v[216:231], a[144:147], v[184:187], 0
    ds_read_b64_tr_b16 a[168:169], v2 offset:51200
    ds_read_b64_tr_b16 a[170:171], v2 offset:52480
    s_waitcnt lgkmcnt(10)
    v_mfma_f32_32x32x16_bf16 v[24:39], a[148:151], v[188:191], v[24:39]
    ds_read_b64_tr_b16 a[172:173], v2 offset:51264
    ds_read_b64_tr_b16 a[174:175], v2 offset:52544
    s_waitcnt lgkmcnt(10)
    v_mfma_f32_32x32x16_bf16 v[40:55], a[152:155], v[188:191], v[40:55]
    ds_read_b64_tr_b16 a[128:129], v2 offset:51328
    ds_read_b64_tr_b16 a[130:131], v2 offset:52608
    s_waitcnt lgkmcnt(10)
    v_mfma_f32_32x32x16_bf16 v[152:167], a[156:159], v[188:191], v[152:167]
    ds_read_b64_tr_b16 a[132:133], v2 offset:51392
    ds_read_b64_tr_b16 a[134:135], v2 offset:52672
    s_waitcnt lgkmcnt(10)
    v_mfma_f32_32x32x16_bf16 v[168:183], a[160:163], v[188:191], v[168:183]
    ds_read_b64_tr_b16 a[136:137], v2 offset:51456
    ds_read_b64_tr_b16 a[138:139], v2 offset:52736
    s_waitcnt lgkmcnt(10)
    v_mfma_f32_32x32x16_bf16 v[216:231], a[164:167], v[188:191], v[216:231]
    ds_read_b64_tr_b16 a[140:141], v2 offset:56320
    ds_read_b64_tr_b16 a[142:143], v2 offset:57600
    s_waitcnt lgkmcnt(10)
    v_mfma_f32_32x32x16_bf16 v[24:39], a[168:171], v[192:195], v[24:39]
    ds_read_b64_tr_b16 a[144:145], v2 offset:56384
    ds_read_b64_tr_b16 a[146:147], v2 offset:57664
    s_waitcnt lgkmcnt(10)
    v_mfma_f32_32x32x16_bf16 v[40:55], a[172:175], v[192:195], v[40:55]
    ds_read_b64_tr_b16 a[148:149], v2 offset:56448
    ds_read_b64_tr_b16 a[150:151], v2 offset:57728
    s_waitcnt lgkmcnt(10)
    v_mfma_f32_32x32x16_bf16 v[152:167], a[128:131], v[192:195], v[152:167]
    ds_read_b64_tr_b16 a[152:153], v2 offset:56512
    ds_read_b64_tr_b16 a[154:155], v2 offset:57792
    s_waitcnt lgkmcnt(10)
    v_mfma_f32_32x32x16_bf16 v[168:183], a[132:135], v[192:195], v[168:183]
    ds_read_b64_tr_b16 a[156:157], v2 offset:56576
    ds_read_b64_tr_b16 a[158:159], v2 offset:57856
    s_waitcnt lgkmcnt(10)
    v_mfma_f32_32x32x16_bf16 v[216:231], a[136:139], v[192:195], v[216:231]
    ds_read_b64_tr_b16 a[160:161], v3 offset:0
    ds_read_b64_tr_b16 a[162:163], v3 offset:1280
    s_waitcnt lgkmcnt(10)
    v_mfma_f32_32x32x16_bf16 v[24:39], a[140:143], v[196:199], v[24:39]
    ds_read_b64_tr_b16 a[164:165], v3 offset:64
    ds_read_b64_tr_b16 a[166:167], v3 offset:1344
    s_waitcnt lgkmcnt(10)
    v_mfma_f32_32x32x16_bf16 v[40:55], a[144:147], v[196:199], v[40:55]
    ds_read_b64_tr_b16 a[168:169], v3 offset:128
    ds_read_b64_tr_b16 a[170:171], v3 offset:1408
    s_waitcnt lgkmcnt(10)
    v_mfma_f32_32x32x16_bf16 v[152:167], a[148:151], v[196:199], v[152:167]
    ds_read_b64_tr_b16 a[172:173], v3 offset:192
    ds_read_b64_tr_b16 a[174:175], v3 offset:1472
    s_waitcnt lgkmcnt(10)
    v_mfma_f32_32x32x16_bf16 v[168:183], a[152:155], v[196:199], v[168:183]
    ds_read_b64_tr_b16 a[128:129], v3 offset:256
    ds_read_b64_tr_b16 a[130:131], v3 offset:1536
    s_waitcnt lgkmcnt(10)
    v_mfma_f32_32x32x16_bf16 v[216:231], a[156:159], v[196:199], v[216:231]
    ds_read_b64_tr_b16 a[132:133], v3 offset:5120
    ds_read_b64_tr_b16 a[134:135], v3 offset:6400
    s_waitcnt lgkmcnt(10)
    v_mfma_f32_32x32x16_bf16 v[24:39], a[160:163], v[200:203], v[24:39]
    ds_read_b64_tr_b16 a[136:137], v3 offset:5184
    ds_read_b64_tr_b16 a[138:139], v3 offset:6464
    s_waitcnt lgkmcnt(10)
    v_mfma_f32_32x32x16_bf16 v[40:55], a[164:167], v[200:203], v[40:55]
    ds_read_b64_tr_b16 a[140:141], v3 offset:5248
    ds_read_b64_tr_b16 a[142:143], v3 offset:6528
    s_waitcnt lgkmcnt(10)
    v_mfma_f32_32x32x16_bf16 v[152:167], a[168:171], v[200:203], v[152:167]
    ds_read_b64_tr_b16 a[144:145], v3 offset:5312
    ds_read_b64_tr_b16 a[146:147], v3 offset:6592
    s_waitcnt lgkmcnt(10)
    v_mfma_f32_32x32x16_bf16 v[168:183], a[172:175], v[200:203], v[168:183]
    ds_read_b64_tr_b16 a[148:149], v3 offset:5376
    ds_read_b64_tr_b16 a[150:151], v3 offset:6656
    s_waitcnt vmcnt(0)
    s_barrier
    s_waitcnt lgkmcnt(10)
    v_mfma_f32_32x32x16_bf16 v[216:231], a[128:131], v[200:203], v[216:231]
    ds_read_b64_tr_b16 a[152:153], v3 offset:10240
    ds_read_b64_tr_b16 a[154:155], v3 offset:11520
    s_waitcnt lgkmcnt(10)
    v_mfma_f32_32x32x16_bf16 v[24:39], a[132:135], v[204:207], v[24:39]
    ds_read_b64_tr_b16 a[156:157], v3 offset:10304
    ds_read_b64_tr_b16 a[158:159], v3 offset:11584
    s_waitcnt lgkmcnt(10)
    v_mfma_f32_32x32x16_bf16 v[40:55], a[136:139], v[204:207], v[40:55]
    ds_read_b64_tr_b16 a[160:161], v3 offset:10368
    ds_read_b64_tr_b16 a[162:163], v3 offset:11648
    s_waitcnt lgkmcnt(10)
    v_mfma_f32_32x32x16_bf16 v[152:167], a[140:143], v[204:207], v[152:167]
    ds_read_b64_tr_b16 a[164:165], v3 offset:10432
    ds_read_b64_tr_b16 a[166:167], v3 offset:11712
    s_waitcnt lgkmcnt(10)
    v_mfma_f32_32x32x16_bf16 v[168:183], a[144:147], v[204:207], v[168:183]
    ds_read_b64_tr_b16 a[168:169], v3 offset:10496
    ds_read_b64_tr_b16 a[170:171], v3 offset:11776
    s_waitcnt lgkmcnt(10)
    v_mfma_f32_32x32x16_bf16 v[216:231], a[148:151], v[204:207], v[216:231]
    ds_read_b64_tr_b16 a[172:173], v3 offset:15360
    ds_read_b64_tr_b16 a[174:175], v3 offset:16640
    s_waitcnt lgkmcnt(10)
    v_mfma_f32_32x32x16_bf16 v[24:39], a[152:155], v[208:211], v[24:39]
    ds_read_b64_tr_b16 a[128:129], v3 offset:15424
    ds_read_b64_tr_b16 a[130:131], v3 offset:16704
    s_waitcnt lgkmcnt(10)
    v_mfma_f32_32x32x16_bf16 v[40:55], a[156:159], v[208:211], v[40:55]
    ds_read_b64_tr_b16 a[132:133], v3 offset:15488
    ds_read_b64_tr_b16 a[134:135], v3 offset:16768
    s_waitcnt lgkmcnt(10)
    v_mfma_f32_32x32x16_bf16 v[152:167], a[160:163], v[208:211], v[152:167]
    ds_read_b64_tr_b16 a[136:137], v3 offset:15552
    ds_read_b64_tr_b16 a[138:139], v3 offset:16832
    s_waitcnt lgkmcnt(10)
    v_mfma_f32_32x32x16_bf16 v[168:183], a[164:167], v[208:211], v[168:183]
    ds_read_b64_tr_b16 a[140:141], v3 offset:15616
    ds_read_b64_tr_b16 a[142:143], v3 offset:16896
    s_waitcnt lgkmcnt(10)
    v_mfma_f32_32x32x16_bf16 v[216:231], a[168:171], v[208:211], v[216:231]
    s_waitcnt lgkmcnt(8)
    v_mfma_f32_32x32x16_bf16 v[24:39], a[172:175], v[212:215], v[24:39]
    s_barrier
    s_add_u32 s42, s14, 1
    s_and_b32 s42, s42, 3
    s_mul_i32 s42, s42, 24576
    s_add_u32 s43, s42, 4096
    buffer_load_dwordx4 v[56:59], v4, s[24:27], s42 offen offset:0
    buffer_load_dwordx4 v[60:63], v4, s[24:27], s42 offen offset:1024
    buffer_load_dwordx4 v[64:67], v4, s[24:27], s42 offen offset:2048
    buffer_load_dwordx4 v[68:71], v4, s[24:27], s42 offen offset:3072
    buffer_load_dwordx4 v[72:75], v4, s[24:27], s43 offen offset:0
    buffer_load_dwordx4 v[76:79], v4, s[24:27], s43 offen offset:1024
    ds_read_b64_tr_b16 a[144:145], v3 offset:20480
    ds_read_b64_tr_b16 a[146:147], v3 offset:21760
    ds_read_b64_tr_b16 a[148:149], v3 offset:20544
    ds_read_b64_tr_b16 a[150:151], v3 offset:21824
    s_waitcnt lgkmcnt(10)
    v_mfma_f32_32x32x16_bf16 v[40:55], a[128:131], v[212:215], v[40:55]
    ds_read_b64_tr_b16 a[152:153], v3 offset:20608
    ds_read_b64_tr_b16 a[154:155], v3 offset:21888
    buffer_load_dwordx4 v[80:83], v4, s[24:27], s43 offen offset:2048
    s_waitcnt lgkmcnt(10)
    v_mfma_f32_32x32x16_bf16 v[152:167], a[132:135], v[212:215], v[152:167]
    ds_read_b64_tr_b16 a[156:157], v3 offset:20672
    ds_read_b64_tr_b16 a[158:159], v3 offset:21952
    s_waitcnt lgkmcnt(10)
    v_mfma_f32_32x32x16_bf16 v[168:183], a[136:139], v[212:215], v[168:183]
    ds_read_b64_tr_b16 a[160:161], v3 offset:20736
    ds_read_b64_tr_b16 a[162:163], v3 offset:22016
    s_waitcnt lgkmcnt(10)
    v_mfma_f32_32x32x16_bf16 v[216:231], a[140:143], v[212:215], v[216:231]
    ds_read_b64_tr_b16 a[164:165], v3 offset:25600
    ds_read_b64_tr_b16 a[166:167], v3 offset:26880
    buffer_load_dwordx4 v[84:87], v4, s[24:27], s43 offen offset:3072
    s_waitcnt lgkmcnt(10)
    s_waitcnt vmcnt(7)
    v_mfma_f32_32x32x16_bf16 v[24:39], a[144:147], v[56:59], v[24:39]
    ds_read_b64_tr_b16 a[168:169], v3 offset:25664
    ds_read_b64_tr_b16 a[170:171], v3 offset:26944
    s_waitcnt lgkmcnt(10)
    v_mfma_f32_32x32x16_bf16 v[40:55], a[148:151], v[56:59], v[40:55]
    ds_read_b64_tr_b16 a[172:173], v3 offset:25728
    ds_read_b64_tr_b16 a[174:175], v3 offset:27008
    s_waitcnt lgkmcnt(10)
    v_mfma_f32_32x32x16_bf16 v[152:167], a[152:155], v[56:59], v[152:167]
    ds_read_b64_tr_b16 a[128:129], v3 offset:25792
    ds_read_b64_tr_b16 a[130:131], v3 offset:27072
    s_add_u32 s44, s14, 2
    s_and_b32 s44, s44, 3
    s_mul_i32 s44, s44, 24576
    s_add_u32 s45, s44, 4096
    buffer_load_dwordx4 v[88:91], v4, s[24:27], s44 offen offset:0
    s_waitcnt lgkmcnt(10)
    v_mfma_f32_32x32x16_bf16 v[168:183], a[156:159], v[56:59], v[168:183]
    ds_read_b64_tr_b16 a[132:133], v3 offset:25856
    ds_read_b64_tr_b16 a[134:135], v3 offset:27136
    s_waitcnt lgkmcnt(10)
    v_mfma_f32_32x32x16_bf16 v[216:231], a[160:163], v[56:59], v[216:231]
    ds_read_b64_tr_b16 a[136:137], v3 offset:30720
    ds_read_b64_tr_b16 a[138:139], v3 offset:32000
    s_waitcnt lgkmcnt(10)
    s_waitcnt vmcnt(7)
    v_mfma_f32_32x32x16_bf16 v[24:39], a[164:167], v[60:63], v[24:39]
    ds_read_b64_tr_b16 a[140:141], v3 offset:30784
    ds_read_b64_tr_b16 a[142:143], v3 offset:32064
    buffer_load_dwordx4 v[92:95], v4, s[24:27], s44 offen offset:1024
    s_waitcnt lgkmcnt(10)
    v_mfma_f32_32x32x16_bf16 v[40:55], a[168:171], v[60:63], v[40:55]
    ds_read_b64_tr_b16 a[144:145], v3 offset:30848
    ds_read_b64_tr_b16 a[146:147], v3 offset:32128
    s_waitcnt lgkmcnt(10)
    v_mfma_f32_32x32x16_bf16 v[152:167], a[172:175], v[60:63], v[152:167]
    ds_read_b64_tr_b16 a[148:149], v3 offset:30912
    ds_read_b64_tr_b16 a[150:151], v3 offset:32192
    s_waitcnt lgkmcnt(10)
    v_mfma_f32_32x32x16_bf16 v[168:183], a[128:131], v[60:63], v[168:183]
    ds_read_b64_tr_b16 a[152:153], v3 offset:30976
    ds_read_b64_tr_b16 a[154:155], v3 offset:32256
    buffer_load_dwordx4 v[96:99], v4, s[24:27], s44 offen offset:2048
    s_waitcnt lgkmcnt(10)
    v_mfma_f32_32x32x16_bf16 v[216:231], a[132:135], v[60:63], v[216:231]
    ds_read_b64_tr_b16 a[156:157], v3 offset:35840
    ds_read_b64_tr_b16 a[158:159], v3 offset:37120
    s_waitcnt lgkmcnt(10)
    s_waitcnt vmcnt(8)
    v_mfma_f32_32x32x16_bf16 v[24:39], a[136:139], v[64:67], v[24:39]
    ds_read_b64_tr_b16 a[160:161], v3 offset:35904
    ds_read_b64_tr_b16 a[162:163], v3 offset:37184
    s_waitcnt lgkmcnt(10)
    v_mfma_f32_32x32x16_bf16 v[40:55], a[140:143], v[64:67], v[40:55]
    ds_read_b64_tr_b16 a[164:165], v3 offset:35968
    ds_read_b64_tr_b16 a[166:167], v3 offset:37248
    buffer_load_dwordx4 v[100:103], v4, s[24:27], s44 offen offset:3072
    s_waitcnt lgkmcnt(10)
    v_mfma_f32_32x32x16_bf16 v[152:167], a[144:147], v[64:67], v[152:167]
    ds_read_b64_tr_b16 a[168:169], v3 offset:36032
    ds_read_b64_tr_b16 a[170:171], v3 offset:37312
    s_waitcnt lgkmcnt(10)
    v_mfma_f32_32x32x16_bf16 v[168:183], a[148:151], v[64:67], v[168:183]
    ds_read_b64_tr_b16 a[172:173], v3 offset:36096
    ds_read_b64_tr_b16 a[174:175], v3 offset:37376
    s_waitcnt lgkmcnt(10)
    v_mfma_f32_32x32x16_bf16 v[216:231], a[152:155], v[64:67], v[216:231]
    ds_read_b64_tr_b16 a[128:129], v1 offset:0
    ds_read_b64_tr_b16 a[130:131], v1 offset:1280
    buffer_load_dwordx4 v[104:107], v4, s[24:27], s45 offen offset:0
    s_waitcnt lgkmcnt(10)
    s_waitcnt vmcnt(9)
    v_mfma_f32_32x32x16_bf16 v[24:39], a[156:159], v[68:71], v[24:39]
    ds_read_b64_tr_b16 a[132:133], v1 offset:64
    ds_read_b64_tr_b16 a[134:135], v1 offset:1344
    s_waitcnt lgkmcnt(10)
    v_mfma_f32_32x32x16_bf16 v[40:55], a[160:163], v[68:71], v[40:55]
    ds_read_b64_tr_b16 a[136:137], v1 offset:128
    ds_read_b64_tr_b16 a[138:139], v1 offset:1408
    s_waitcnt lgkmcnt(10)
    v_mfma_f32_32x32x16_bf16 v[152:167], a[164:167], v[68:71], v[152:167]
    ds_read_b64_tr_b16 a[140:141], v1 offset:192
    ds_read_b64_tr_b16 a[142:143], v1 offset:1472
    buffer_load_dwordx4 v[108:111], v4, s[24:27], s45 offen offset:1024
    s_waitcnt lgkmcnt(10)
    v_mfma_f32_32x32x16_bf16 v[168:183], a[168:171], v[68:71], v[168:183]
    ds_read_b64_tr_b16 a[144:145], v1 offset:256
    ds_read_b64_tr_b16 a[146:147], v1 offset:1536
    s_waitcnt lgkmcnt(10)
    v_mfma_f32_32x32x16_bf16 v[216:231], a[172:175], v[68:71], v[216:231]
    ds_read_b64_tr_b16 a[148:149], v1 offset:5120
    ds_read_b64_tr_b16 a[150:151], v1 offset:6400
    s_waitcnt lgkmcnt(10)
    s_waitcnt vmcnt(9)
    v_mfma_f32_32x32x16_bf16 v[24:39], a[128:131], v[72:75], v[24:39]
    ds_read_b64_tr_b16 a[152:153], v1 offset:5184
    ds_read_b64_tr_b16 a[154:155], v1 offset:6464
    buffer_load_dwordx4 v[112:115], v4, s[24:27], s45 offen offset:2048
    s_waitcnt lgkmcnt(10)
    v_mfma_f32_32x32x16_bf16 v[40:55], a[132:135], v[72:75], v[40:55]
    ds_read_b64_tr_b16 a[156:157], v1 offset:5248
    ds_read_b64_tr_b16 a[158:159], v1 offset:6528
    s_waitcnt lgkmcnt(10)
    v_mfma_f32_32x32x16_bf16 v[152:167], a[136:139], v[72:75], v[152:167]
    ds_read_b64_tr_b16 a[160:161], v1 offset:5312
    ds_read_b64_tr_b16 a[162:163], v1 offset:6592
    s_waitcnt lgkmcnt(10)
    v_mfma_f32_32x32x16_bf16 v[168:183], a[140:143], v[72:75], v[168:183]
    ds_read_b64_tr_b16 a[164:165], v1 offset:5376
    ds_read_b64_tr_b16 a[166:167], v1 offset:6656
    buffer_load_dwordx4 v[116:119], v4, s[24:27], s45 offen offset:3072
    s_waitcnt lgkmcnt(10)
    v_mfma_f32_32x32x16_bf16 v[216:231], a[144:147], v[72:75], v[216:231]
    ds_read_b64_tr_b16 a[168:169], v1 offset:10240
    ds_read_b64_tr_b16 a[170:171], v1 offset:11520
    s_waitcnt lgkmcnt(10)
    s_waitcnt vmcnt(10)
    v_mfma_f32_32x32x16_bf16 v[24:39], a[148:151], v[76:79], v[24:39]
    ds_read_b64_tr_b16 a[172:173], v1 offset:10304
    ds_read_b64_tr_b16 a[174:175], v1 offset:11584
    s_waitcnt lgkmcnt(10)
    v_mfma_f32_32x32x16_bf16 v[40:55], a[152:155], v[76:79], v[40:55]
    ds_read_b64_tr_b16 a[128:129], v1 offset:10368
    ds_read_b64_tr_b16 a[130:131], v1 offset:11648
    s_add_u32 s42, s14, 3
    s_and_b32 s42, s42, 3
    s_mul_i32 s42, s42, 24576
    s_add_u32 s43, s42, 4096
    buffer_load_dwordx4 v[120:123], v4, s[24:27], s42 offen offset:0
    s_waitcnt lgkmcnt(10)
    v_mfma_f32_32x32x16_bf16 v[152:167], a[156:159], v[76:79], v[152:167]
    ds_read_b64_tr_b16 a[132:133], v1 offset:10432
    ds_read_b64_tr_b16 a[134:135], v1 offset:11712
    s_waitcnt lgkmcnt(10)
    v_mfma_f32_32x32x16_bf16 v[168:183], a[160:163], v[76:79], v[168:183]
    ds_read_b64_tr_b16 a[136:137], v1 offset:10496
    ds_read_b64_tr_b16 a[138:139], v1 offset:11776
    s_waitcnt lgkmcnt(10)
    v_mfma_f32_32x32x16_bf16 v[216:231], a[164:167], v[76:79], v[216:231]
    ds_read_b64_tr_b16 a[140:141], v1 offset:15360
    ds_read_b64_tr_b16 a[142:143], v1 offset:16640
    buffer_load_dwordx4 v[124:127], v4, s[24:27], s42 offen offset:1024
    s_waitcnt lgkmcnt(10)
    s_waitcnt vmcnt(11)
    v_mfma_f32_32x32x16_bf16 v[24:39], a[168:171], v[80:83], v[24:39]
    ds_read_b64_tr_b16 a[144:145], v1 offset:15424
    ds_read_b64_tr_b16 a[146:147], v1 offset:16704
    s_waitcnt lgkmcnt(10)
    v_mfma_f32_32x32x16_bf16 v[40:55], a[172:175], v[80:83], v[40:55]
    ds_read_b64_tr_b16 a[148:149], v1 offset:15488
    ds_read_b64_tr_b16 a[150:151], v1 offset:16768
    s_waitcnt lgkmcnt(10)
    v_mfma_f32_32x32x16_bf16 v[152:167], a[128:131], v[80:83], v[152:167]
    ds_read_b64_tr_b16 a[152:153], v1 offset:15552
    ds_read_b64_tr_b16 a[154:155], v1 offset:16832
    buffer_load_dwordx4 v[128:131], v4, s[24:27], s42 offen offset:2048
    s_waitcnt lgkmcnt(10)
    v_mfma_f32_32x32x16_bf16 v[168:183], a[132:135], v[80:83], v[168:183]
    ds_read_b64_tr_b16 a[156:157], v1 offset:15616
    ds_read_b64_tr_b16 a[158:159], v1 offset:16896
    s_waitcnt lgkmcnt(10)
    v_mfma_f32_32x32x16_bf16 v[216:231], a[136:139], v[80:83], v[216:231]
    ds_read_b64_tr_b16 a[160:161], v1 offset:20480
    ds_read_b64_tr_b16 a[162:163], v1 offset:21760
    s_waitcnt lgkmcnt(10)
    s_waitcnt vmcnt(11)
    v_mfma_f32_32x32x16_bf16 v[24:39], a[140:143], v[84:87], v[24:39]
    ds_read_b64_tr_b16 a[164:165], v1 offset:20544
    ds_read_b64_tr_b16 a[166:167], v1 offset:21824
    buffer_load_dwordx4 v[132:135], v4, s[24:27], s42 offen offset:3072
    s_waitcnt lgkmcnt(10)
    v_mfma_f32_32x32x16_bf16 v[40:55], a[144:147], v[84:87], v[40:55]
    ds_read_b64_tr_b16 a[168:169], v1 offset:25600
    ds_read_b64_tr_b16 a[170:171], v1 offset:26880
    s_waitcnt lgkmcnt(10)
    v_mfma_f32_32x32x16_bf16 v[152:167], a[148:151], v[84:87], v[152:167]
    ds_read_b64_tr_b16 a[172:173], v1 offset:25664
    ds_read_b64_tr_b16 a[174:175], v1 offset:26944
    s_waitcnt lgkmcnt(10)
    v_mfma_f32_32x32x16_bf16 v[168:183], a[152:155], v[84:87], v[168:183]
    ds_read_b64_tr_b16 a[128:129], v1 offset:30720
    ds_read_b64_tr_b16 a[130:131], v1 offset:32000
    buffer_load_dwordx4 v[136:139], v4, s[24:27], s43 offen offset:0
    s_waitcnt lgkmcnt(10)
    v_mfma_f32_32x32x16_bf16 v[216:231], a[156:159], v[84:87], v[216:231]
    ds_read_b64_tr_b16 a[132:133], v1 offset:30784
    ds_read_b64_tr_b16 a[134:135], v1 offset:32064
    s_waitcnt lgkmcnt(10)
    s_waitcnt vmcnt(12)
    v_mfma_f32_32x32x16_bf16 v[24:39], a[160:163], v[88:91], v[24:39]
    ds_read_b64_tr_b16 a[136:137], v1 offset:35840
    ds_read_b64_tr_b16 a[138:139], v1 offset:37120
    s_waitcnt lgkmcnt(10)
    v_mfma_f32_32x32x16_bf16 v[40:55], a[164:167], v[88:91], v[40:55]
    ds_read_b64_tr_b16 a[140:141], v1 offset:35904
    ds_read_b64_tr_b16 a[142:143], v1 offset:37184
    buffer_load_dwordx4 v[140:143], v4, s[24:27], s43 offen offset:1024
    s_waitcnt lgkmcnt(10)
    s_waitcnt vmcnt(12)
    v_mfma_f32_32x32x16_bf16 v[24:39], a[168:171], v[92:95], v[24:39]
    ds_read_b64_tr_b16 a[144:145], v1 offset:40960
    ds_read_b64_tr_b16 a[146:147], v1 offset:42240
    s_waitcnt lgkmcnt(10)
    v_mfma_f32_32x32x16_bf16 v[40:55], a[172:175], v[92:95], v[40:55]
    ds_read_b64_tr_b16 a[148:149], v1 offset:41024
    ds_read_b64_tr_b16 a[150:151], v1 offset:42304
    s_waitcnt lgkmcnt(10)
    s_waitcnt vmcnt(11)
    v_mfma_f32_32x32x16_bf16 v[24:39], a[128:131], v[96:99], v[24:39]
    ds_read_b64_tr_b16 a[152:153], v1 offset:46080
    ds_read_b64_tr_b16 a[154:155], v1 offset:47360
    buffer_load_dwordx4 v[144:147], v4, s[24:27], s43 offen offset:2048
    s_waitcnt lgkmcnt(10)
    v_mfma_f32_32x32x16_bf16 v[40:55], a[132:135], v[96:99], v[40:55]
    ds_read_b64_tr_b16 a[156:157], v1 offset:46144
    ds_read_b64_tr_b16 a[158:159], v1 offset:47424
    s_waitcnt lgkmcnt(10)
    s_waitcnt vmcnt(11)
    v_mfma_f32_32x32x16_bf16 v[24:39], a[136:139], v[100:103], v[24:39]
    ds_read_b64_tr_b16 a[160:161], v1 offset:51200
    ds_read_b64_tr_b16 a[162:163], v1 offset:52480
    s_waitcnt lgkmcnt(10)
    v_mfma_f32_32x32x16_bf16 v[40:55], a[140:143], v[100:103], v[40:55]
    ds_read_b64_tr_b16 a[164:165], v1 offset:51264
    ds_read_b64_tr_b16 a[166:167], v1 offset:52544
    buffer_load_dwordx4 v[148:151], v4, s[24:27], s43 offen offset:3072
    s_waitcnt lgkmcnt(10)
    s_waitcnt vmcnt(11)
    v_mfma_f32_32x32x16_bf16 v[24:39], a[144:147], v[104:107], v[24:39]
    ds_read_b64_tr_b16 a[168:169], v1 offset:56320
    ds_read_b64_tr_b16 a[170:171], v1 offset:57600
    s_waitcnt lgkmcnt(10)
    v_mfma_f32_32x32x16_bf16 v[40:55], a[148:151], v[104:107], v[40:55]
    ds_read_b64_tr_b16 a[172:173], v1 offset:56384
    ds_read_b64_tr_b16 a[174:175], v1 offset:57664
    s_waitcnt lgkmcnt(10)
    s_waitcnt vmcnt(10)
    v_mfma_f32_32x32x16_bf16 v[24:39], a[152:155], v[108:111], v[24:39]
    ds_read_b64_tr_b16 a[128:129], v2 offset:0
    ds_read_b64_tr_b16 a[130:131], v2 offset:1280
    s_waitcnt lgkmcnt(10)
    v_mfma_f32_32x32x16_bf16 v[40:55], a[156:159], v[108:111], v[40:55]
    ds_read_b64_tr_b16 a[132:133], v2 offset:64
    ds_read_b64_tr_b16 a[134:135], v2 offset:1344
    s_waitcnt lgkmcnt(10)
    s_waitcnt vmcnt(9)
    v_mfma_f32_32x32x16_bf16 v[24:39], a[160:163], v[112:115], v[24:39]
    ds_read_b64_tr_b16 a[136:137], v2 offset:5120
    ds_read_b64_tr_b16 a[138:139], v2 offset:6400
    s_waitcnt lgkmcnt(10)
    v_mfma_f32_32x32x16_bf16 v[40:55], a[164:167], v[112:115], v[40:55]
    ds_read_b64_tr_b16 a[140:141], v2 offset:5184
    ds_read_b64_tr_b16 a[142:143], v2 offset:6464
    s_waitcnt lgkmcnt(10)
    s_waitcnt vmcnt(8)
    v_mfma_f32_32x32x16_bf16 v[24:39], a[168:171], v[116:119], v[24:39]
    ds_read_b64_tr_b16 a[144:145], v2 offset:10240
    ds_read_b64_tr_b16 a[146:147], v2 offset:11520
    s_waitcnt lgkmcnt(10)
    v_mfma_f32_32x32x16_bf16 v[40:55], a[172:175], v[116:119], v[40:55]
    ds_read_b64_tr_b16 a[148:149], v2 offset:10304
    ds_read_b64_tr_b16 a[150:151], v2 offset:11584
    s_waitcnt lgkmcnt(10)
    s_waitcnt vmcnt(7)
    v_mfma_f32_32x32x16_bf16 v[24:39], a[128:131], v[120:123], v[24:39]
    ds_read_b64_tr_b16 a[152:153], v2 offset:15360
    ds_read_b64_tr_b16 a[154:155], v2 offset:16640
    s_waitcnt lgkmcnt(10)
    v_mfma_f32_32x32x16_bf16 v[40:55], a[132:135], v[120:123], v[40:55]
    ds_read_b64_tr_b16 a[156:157], v2 offset:15424
    ds_read_b64_tr_b16 a[158:159], v2 offset:16704
    s_waitcnt lgkmcnt(10)
    s_waitcnt vmcnt(6)
    v_mfma_f32_32x32x16_bf16 v[24:39], a[136:139], v[124:127], v[24:39]
    ds_read_b64_tr_b16 a[160:161], v2 offset:20480
    ds_read_b64_tr_b16 a[162:163], v2 offset:21760
    s_waitcnt lgkmcnt(10)
    v_mfma_f32_32x32x16_bf16 v[40:55], a[140:143], v[124:127], v[40:55]
    ds_read_b64_tr_b16 a[164:165], v2 offset:20544
    ds_read_b64_tr_b16 a[166:167], v2 offset:21824
    s_waitcnt lgkmcnt(10)
    s_waitcnt vmcnt(5)
    v_mfma_f32_32x32x16_bf16 v[24:39], a[144:147], v[128:131], v[24:39]
    ds_read_b64_tr_b16 a[168:169], v2 offset:25600
    ds_read_b64_tr_b16 a[170:171], v2 offset:26880
    s_waitcnt lgkmcnt(10)
    v_mfma_f32_32x32x16_bf16 v[40:55], a[148:151], v[128:131], v[40:55]
    ds_read_b64_tr_b16 a[172:173], v2 offset:25664
    ds_read_b64_tr_b16 a[174:175], v2 offset:26944
    s_waitcnt lgkmcnt(10)
    s_waitcnt vmcnt(4)
    v_mfma_f32_32x32x16_bf16 v[24:39], a[152:155], v[132:135], v[24:39]
    ds_read_b64_tr_b16 a[128:129], v2 offset:30720
    ds_read_b64_tr_b16 a[130:131], v2 offset:32000
    s_waitcnt lgkmcnt(10)
    v_mfma_f32_32x32x16_bf16 v[40:55], a[156:159], v[132:135], v[40:55]
    ds_read_b64_tr_b16 a[132:133], v2 offset:30784
    ds_read_b64_tr_b16 a[134:135], v2 offset:32064
    s_waitcnt lgkmcnt(10)
    s_waitcnt vmcnt(3)
    v_mfma_f32_32x32x16_bf16 v[24:39], a[160:163], v[136:139], v[24:39]
    ds_read_b64_tr_b16 a[136:137], v2 offset:35840
    ds_read_b64_tr_b16 a[138:139], v2 offset:37120
    s_waitcnt lgkmcnt(10)
    v_mfma_f32_32x32x16_bf16 v[40:55], a[164:167], v[136:139], v[40:55]
    ds_read_b64_tr_b16 a[140:141], v2 offset:35904
    ds_read_b64_tr_b16 a[142:143], v2 offset:37184
    s_waitcnt lgkmcnt(10)
    s_waitcnt vmcnt(2)
    v_mfma_f32_32x32x16_bf16 v[24:39], a[168:171], v[140:143], v[24:39]
    ds_read_b64_tr_b16 a[144:145], v1 offset:20608
    ds_read_b64_tr_b16 a[146:147], v1 offset:21888
    s_waitcnt lgkmcnt(10)
    v_mfma_f32_32x32x16_bf16 v[40:55], a[172:175], v[140:143], v[40:55]
    ds_read_b64_tr_b16 a[148:149], v1 offset:20672
    ds_read_b64_tr_b16 a[150:151], v1 offset:21952
    s_waitcnt lgkmcnt(10)
    s_waitcnt vmcnt(1)
    v_mfma_f32_32x32x16_bf16 v[24:39], a[128:131], v[144:147], v[24:39]
    ds_read_b64_tr_b16 a[152:153], v1 offset:25728
    ds_read_b64_tr_b16 a[154:155], v1 offset:27008
    s_waitcnt lgkmcnt(10)
    v_mfma_f32_32x32x16_bf16 v[40:55], a[132:135], v[144:147], v[40:55]
    ds_read_b64_tr_b16 a[156:157], v1 offset:25792
    ds_read_b64_tr_b16 a[158:159], v1 offset:27072
    s_waitcnt lgkmcnt(10)
    s_waitcnt vmcnt(0)
    v_mfma_f32_32x32x16_bf16 v[24:39], a[136:139], v[148:151], v[24:39]
    ds_read_b64_tr_b16 a[160:161], v1 offset:30848
    ds_read_b64_tr_b16 a[162:163], v1 offset:32128
    s_waitcnt lgkmcnt(10)
    v_mfma_f32_32x32x16_bf16 v[40:55], a[140:143], v[148:151], v[40:55]
    ds_read_b64_tr_b16 a[164:165], v1 offset:30912
    ds_read_b64_tr_b16 a[166:167], v1 offset:32192
    s_waitcnt lgkmcnt(10)
    v_mfma_f32_32x32x16_bf16 v[152:167], a[144:147], v[88:91], v[152:167]
    ds_read_b64_tr_b16 a[168:169], v1 offset:35968
    ds_read_b64_tr_b16 a[170:171], v1 offset:37248
    s_waitcnt lgkmcnt(10)
    v_mfma_f32_32x32x16_bf16 v[168:183], a[148:151], v[88:91], v[168:183]
    ds_read_b64_tr_b16 a[172:173], v1 offset:36032
    ds_read_b64_tr_b16 a[174:175], v1 offset:37312
    v_cvt_pk_bf16_f32 v232, v24, v25
    v_cvt_pk_bf16_f32 v233, v26, v27
    v_cvt_pk_bf16_f32 v234, v28, v29
    s_waitcnt lgkmcnt(10)
    v_mfma_f32_32x32x16_bf16 v[152:167], a[152:155], v[92:95], v[152:167]
    ds_read_b64_tr_b16 a[128:129], v1 offset:41088
    ds_read_b64_tr_b16 a[130:131], v1 offset:42368
    v_cvt_pk_bf16_f32 v235, v30, v31
    buffer_store_dwordx4 v[232:235], v13, s[28:31], s46 offen offset:0 sc1
    v_cvt_pk_bf16_f32 v236, v32, v33
    s_waitcnt lgkmcnt(10)
    v_mfma_f32_32x32x16_bf16 v[168:183], a[156:159], v[92:95], v[168:183]
    ds_read_b64_tr_b16 a[132:133], v1 offset:41152
    ds_read_b64_tr_b16 a[134:135], v1 offset:42432
    v_cvt_pk_bf16_f32 v237, v34, v35
    v_cvt_pk_bf16_f32 v238, v36, v37
    v_cvt_pk_bf16_f32 v239, v38, v39
    s_waitcnt lgkmcnt(10)
    v_mfma_f32_32x32x16_bf16 v[152:167], a[160:163], v[96:99], v[152:167]
    ds_read_b64_tr_b16 a[136:137], v1 offset:46208
    ds_read_b64_tr_b16 a[138:139], v1 offset:47488
    buffer_store_dwordx4 v[236:239], v13, s[28:31], s46 offen offset:1024 sc1
    v_cvt_pk_bf16_f32 v240, v40, v41
    v_cvt_pk_bf16_f32 v241, v42, v43
    s_waitcnt lgkmcnt(10)
    v_mfma_f32_32x32x16_bf16 v[168:183], a[164:167], v[96:99], v[168:183]
    ds_read_b64_tr_b16 a[140:141], v1 offset:46272
    ds_read_b64_tr_b16 a[142:143], v1 offset:47552
    v_cvt_pk_bf16_f32 v242, v44, v45
    v_cvt_pk_bf16_f32 v243, v46, v47
    buffer_store_dwordx4 v[240:243], v13, s[28:31], s46 offen offset:2048 sc1
    s_waitcnt lgkmcnt(10)
    v_mfma_f32_32x32x16_bf16 v[152:167], a[168:171], v[100:103], v[152:167]
    ds_read_b64_tr_b16 a[144:145], v1 offset:51328
    ds_read_b64_tr_b16 a[146:147], v1 offset:52608
    v_cvt_pk_bf16_f32 v244, v48, v49
    v_cvt_pk_bf16_f32 v245, v50, v51
    v_cvt_pk_bf16_f32 v246, v52, v53
    s_waitcnt lgkmcnt(10)
    v_mfma_f32_32x32x16_bf16 v[168:183], a[172:175], v[100:103], v[168:183]
    ds_read_b64_tr_b16 a[148:149], v1 offset:51392
    ds_read_b64_tr_b16 a[150:151], v1 offset:52672
    v_cvt_pk_bf16_f32 v247, v54, v55
    buffer_store_dwordx4 v[244:247], v13, s[28:31], s46 offen offset:3072 sc1
    s_waitcnt lgkmcnt(10)
    v_mfma_f32_32x32x16_bf16 v[152:167], a[128:131], v[104:107], v[152:167]
    ds_read_b64_tr_b16 a[152:153], v1 offset:56448
    ds_read_b64_tr_b16 a[154:155], v1 offset:57728
    s_waitcnt lgkmcnt(10)
    v_mfma_f32_32x32x16_bf16 v[168:183], a[132:135], v[104:107], v[168:183]
    ds_read_b64_tr_b16 a[156:157], v1 offset:56512
    ds_read_b64_tr_b16 a[158:159], v1 offset:57792
    s_waitcnt lgkmcnt(10)
    v_mfma_f32_32x32x16_bf16 v[152:167], a[136:139], v[108:111], v[152:167]
    ds_read_b64_tr_b16 a[160:161], v2 offset:128
    ds_read_b64_tr_b16 a[162:163], v2 offset:1408
    s_waitcnt lgkmcnt(10)
    v_mfma_f32_32x32x16_bf16 v[168:183], a[140:143], v[108:111], v[168:183]
    ds_read_b64_tr_b16 a[164:165], v2 offset:192
    ds_read_b64_tr_b16 a[166:167], v2 offset:1472
    s_waitcnt lgkmcnt(10)
    v_mfma_f32_32x32x16_bf16 v[152:167], a[144:147], v[112:115], v[152:167]
    ds_read_b64_tr_b16 a[168:169], v2 offset:5248
    ds_read_b64_tr_b16 a[170:171], v2 offset:6528
    s_waitcnt lgkmcnt(10)
    v_mfma_f32_32x32x16_bf16 v[168:183], a[148:151], v[112:115], v[168:183]
    ds_read_b64_tr_b16 a[172:173], v2 offset:5312
    ds_read_b64_tr_b16 a[174:175], v2 offset:6592
    s_waitcnt lgkmcnt(10)
    v_mfma_f32_32x32x16_bf16 v[152:167], a[152:155], v[116:119], v[152:167]
    ds_read_b64_tr_b16 a[128:129], v2 offset:10368
    ds_read_b64_tr_b16 a[130:131], v2 offset:11648
    s_waitcnt lgkmcnt(10)
    v_mfma_f32_32x32x16_bf16 v[168:183], a[156:159], v[116:119], v[168:183]
    ds_read_b64_tr_b16 a[132:133], v2 offset:10432
    ds_read_b64_tr_b16 a[134:135], v2 offset:11712
    s_waitcnt lgkmcnt(10)
    v_mfma_f32_32x32x16_bf16 v[152:167], a[160:163], v[120:123], v[152:167]
    ds_read_b64_tr_b16 a[136:137], v2 offset:15488
    ds_read_b64_tr_b16 a[138:139], v2 offset:16768
    s_waitcnt lgkmcnt(10)
    v_mfma_f32_32x32x16_bf16 v[168:183], a[164:167], v[120:123], v[168:183]
    ds_read_b64_tr_b16 a[140:141], v2 offset:15552
    ds_read_b64_tr_b16 a[142:143], v2 offset:16832
    s_waitcnt lgkmcnt(10)
    v_mfma_f32_32x32x16_bf16 v[152:167], a[168:171], v[124:127], v[152:167]
    ds_read_b64_tr_b16 a[144:145], v2 offset:20608
    ds_read_b64_tr_b16 a[146:147], v2 offset:21888
    s_waitcnt lgkmcnt(10)
    v_mfma_f32_32x32x16_bf16 v[168:183], a[172:175], v[124:127], v[168:183]
    ds_read_b64_tr_b16 a[148:149], v2 offset:20672
    ds_read_b64_tr_b16 a[150:151], v2 offset:21952
    s_waitcnt lgkmcnt(10)
    v_mfma_f32_32x32x16_bf16 v[152:167], a[128:131], v[128:131], v[152:167]
    ds_read_b64_tr_b16 a[152:153], v2 offset:25728
    ds_read_b64_tr_b16 a[154:155], v2 offset:27008
    s_waitcnt lgkmcnt(10)
    v_mfma_f32_32x32x16_bf16 v[168:183], a[132:135], v[128:131], v[168:183]
    ds_read_b64_tr_b16 a[156:157], v2 offset:25792
    ds_read_b64_tr_b16 a[158:159], v2 offset:27072
    s_waitcnt lgkmcnt(10)
    v_mfma_f32_32x32x16_bf16 v[152:167], a[136:139], v[132:135], v[152:167]
    ds_read_b64_tr_b16 a[160:161], v2 offset:30848
    ds_read_b64_tr_b16 a[162:163], v2 offset:32128
    s_waitcnt lgkmcnt(10)
    v_mfma_f32_32x32x16_bf16 v[168:183], a[140:143], v[132:135], v[168:183]
    ds_read_b64_tr_b16 a[164:165], v2 offset:30912
    ds_read_b64_tr_b16 a[166:167], v2 offset:32192
    s_waitcnt lgkmcnt(10)
    v_mfma_f32_32x32x16_bf16 v[152:167], a[144:147], v[136:139], v[152:167]
    ds_read_b64_tr_b16 a[168:169], v2 offset:35968
    ds_read_b64_tr_b16 a[170:171], v2 offset:37248
    s_waitcnt lgkmcnt(10)
    v_mfma_f32_32x32x16_bf16 v[168:183], a[148:151], v[136:139], v[168:183]
    ds_read_b64_tr_b16 a[172:173], v2 offset:36032
    ds_read_b64_tr_b16 a[174:175], v2 offset:37312
    s_waitcnt lgkmcnt(10)
    v_mfma_f32_32x32x16_bf16 v[152:167], a[152:155], v[140:143], v[152:167]
    ds_read_b64_tr_b16 a[128:129], v1 offset:20736
    ds_read_b64_tr_b16 a[130:131], v1 offset:22016
    s_waitcnt lgkmcnt(10)
    v_mfma_f32_32x32x16_bf16 v[168:183], a[156:159], v[140:143], v[168:183]
    ds_read_b64_tr_b16 a[132:133], v1 offset:25856
    ds_read_b64_tr_b16 a[134:135], v1 offset:27136
    s_waitcnt lgkmcnt(10)
    v_mfma_f32_32x32x16_bf16 v[152:167], a[160:163], v[144:147], v[152:167]
    ds_read_b64_tr_b16 a[136:137], v1 offset:30976
    ds_read_b64_tr_b16 a[138:139], v1 offset:32256
    s_waitcnt lgkmcnt(10)
    v_mfma_f32_32x32x16_bf16 v[168:183], a[164:167], v[144:147], v[168:183]
    ds_read_b64_tr_b16 a[140:141], v1 offset:36096
    ds_read_b64_tr_b16 a[142:143], v1 offset:37376
    s_waitcnt lgkmcnt(10)
    v_mfma_f32_32x32x16_bf16 v[152:167], a[168:171], v[148:151], v[152:167]
    ds_read_b64_tr_b16 a[144:145], v1 offset:41216
    ds_read_b64_tr_b16 a[146:147], v1 offset:42496
    s_waitcnt lgkmcnt(10)
    v_mfma_f32_32x32x16_bf16 v[168:183], a[172:175], v[148:151], v[168:183]
    ds_read_b64_tr_b16 a[148:149], v1 offset:46336
    ds_read_b64_tr_b16 a[150:151], v1 offset:47616
    s_waitcnt lgkmcnt(10)
    v_mfma_f32_32x32x16_bf16 v[216:231], a[128:131], v[88:91], v[216:231]
    ds_read_b64_tr_b16 a[152:153], v1 offset:51456
    ds_read_b64_tr_b16 a[154:155], v1 offset:52736
    s_waitcnt lgkmcnt(10)
    v_mfma_f32_32x32x16_bf16 v[216:231], a[132:135], v[92:95], v[216:231]
    ds_read_b64_tr_b16 a[156:157], v1 offset:56576
    ds_read_b64_tr_b16 a[158:159], v1 offset:57856
    v_cvt_pk_bf16_f32 v232, v152, v153
    v_cvt_pk_bf16_f32 v233, v154, v155
    v_cvt_pk_bf16_f32 v234, v156, v157
    s_waitcnt lgkmcnt(10)
    v_mfma_f32_32x32x16_bf16 v[216:231], a[136:139], v[96:99], v[216:231]
    ds_read_b64_tr_b16 a[160:161], v2 offset:256
    ds_read_b64_tr_b16 a[162:163], v2 offset:1536
    v_cvt_pk_bf16_f32 v235, v158, v159
    buffer_store_dwordx4 v[232:235], v13, s[28:31], s47 offen offset:0 sc1
    v_cvt_pk_bf16_f32 v236, v160, v161
    s_waitcnt lgkmcnt(10)
    v_mfma_f32_32x32x16_bf16 v[216:231], a[140:143], v[100:103], v[216:231]
    ds_read_b64_tr_b16 a[164:165], v2 offset:5376
    ds_read_b64_tr_b16 a[166:167], v2 offset:6656
    v_cvt_pk_bf16_f32 v237, v162, v163
    v_cvt_pk_bf16_f32 v238, v164, v165
    v_cvt_pk_bf16_f32 v239, v166, v167
    s_waitcnt lgkmcnt(10)
    v_mfma_f32_32x32x16_bf16 v[216:231], a[144:147], v[104:107], v[216:231]
    ds_read_b64_tr_b16 a[168:169], v2 offset:10496
    ds_read_b64_tr_b16 a[170:171], v2 offset:11776
    buffer_store_dwordx4 v[236:239], v13, s[28:31], s47 offen offset:1024 sc1
    v_cvt_pk_bf16_f32 v240, v168, v169
    v_cvt_pk_bf16_f32 v241, v170, v171
    s_waitcnt lgkmcnt(10)
    v_mfma_f32_32x32x16_bf16 v[216:231], a[148:151], v[108:111], v[216:231]
    ds_read_b64_tr_b16 a[172:173], v2 offset:15616
    ds_read_b64_tr_b16 a[174:175], v2 offset:16896
    v_cvt_pk_bf16_f32 v242, v172, v173
    v_cvt_pk_bf16_f32 v243, v174, v175
    buffer_store_dwordx4 v[240:243], v13, s[28:31], s47 offen offset:2048 sc1
    s_waitcnt lgkmcnt(10)
    v_mfma_f32_32x32x16_bf16 v[216:231], a[152:155], v[112:115], v[216:231]
    ds_read_b64_tr_b16 a[128:129], v2 offset:20736
    ds_read_b64_tr_b16 a[130:131], v2 offset:22016
    v_cvt_pk_bf16_f32 v244, v176, v177
    v_cvt_pk_bf16_f32 v245, v178, v179
    v_cvt_pk_bf16_f32 v246, v180, v181
    s_waitcnt lgkmcnt(10)
    v_mfma_f32_32x32x16_bf16 v[216:231], a[156:159], v[116:119], v[216:231]
    ds_read_b64_tr_b16 a[132:133], v2 offset:25856
    ds_read_b64_tr_b16 a[134:135], v2 offset:27136
    v_cvt_pk_bf16_f32 v247, v182, v183
    buffer_store_dwordx4 v[244:247], v13, s[28:31], s47 offen offset:3072 sc1
    s_waitcnt lgkmcnt(10)
    v_mfma_f32_32x32x16_bf16 v[216:231], a[160:163], v[120:123], v[216:231]
    ds_read_b64_tr_b16 a[136:137], v2 offset:30976
    ds_read_b64_tr_b16 a[138:139], v2 offset:32256
    s_waitcnt lgkmcnt(10)
    v_mfma_f32_32x32x16_bf16 v[216:231], a[164:167], v[124:127], v[216:231]
    ds_read_b64_tr_b16 a[140:141], v2 offset:36096
    ds_read_b64_tr_b16 a[142:143], v2 offset:37376
    s_waitcnt lgkmcnt(10)
    v_mfma_f32_32x32x16_bf16 v[216:231], a[168:171], v[128:131], v[216:231]
    s_waitcnt lgkmcnt(8)
    v_mfma_f32_32x32x16_bf16 v[216:231], a[172:175], v[132:135], v[216:231]
    s_waitcnt lgkmcnt(6)
    v_mfma_f32_32x32x16_bf16 v[216:231], a[128:131], v[136:139], v[216:231]
    s_waitcnt lgkmcnt(4)
    v_mfma_f32_32x32x16_bf16 v[216:231], a[132:135], v[140:143], v[216:231]
    s_waitcnt lgkmcnt(2)
    v_mfma_f32_32x32x16_bf16 v[216:231], a[136:139], v[144:147], v[216:231]
    s_waitcnt lgkmcnt(0)
    v_mfma_f32_32x32x16_bf16 v[216:231], a[140:143], v[148:151], v[216:231]
    s_nop 11
    v_cvt_pk_bf16_f32 v232, v216, v217
    v_cvt_pk_bf16_f32 v233, v218, v219
    v_cvt_pk_bf16_f32 v234, v220, v221
    v_cvt_pk_bf16_f32 v235, v222, v223
    buffer_store_dwordx4 v[232:235], v13, s[28:31], s40 offen offset:0 sc1
    v_cvt_pk_bf16_f32 v236, v224, v225
    v_cvt_pk_bf16_f32 v237, v226, v227
    v_cvt_pk_bf16_f32 v238, v228, v229
    v_cvt_pk_bf16_f32 v239, v230, v231
    buffer_store_dwordx4 v[236:239], v13, s[28:31], s40 offen offset:1024 sc1
    s_waitcnt vmcnt(0)
    s_barrier
    s_barrier
    s_branch R_start
A_loader:
    v_lshrrev_b32 v1, 4, v0
    v_and_b32 v2, 15, v0
    v_lshlrev_b32 v8, 4, v0
    v_add_u32 v3, 0, v1
    v_xor_b32 v3, v3, v2
    v_lshlrev_b32 v3, 4, v3
    v_lshl_add_u32 v4, v1, 8, v3
    v_add_u32 v12, 0x10000, v4
    v_add_u32 v3, 4, v1
    v_xor_b32 v3, v3, v2
    v_lshlrev_b32 v3, 4, v3
    v_lshl_add_u32 v5, v1, 8, v3
    v_add_u32 v13, 0x10000, v5
    v_add_u32 v3, 8, v1
    v_xor_b32 v3, v3, v2
    v_lshlrev_b32 v3, 4, v3
    v_lshl_add_u32 v6, v1, 8, v3
    v_add_u32 v14, 0x10000, v6
    v_add_u32 v3, 12, v1
    v_xor_b32 v3, v3, v2
    v_lshlrev_b32 v3, 4, v3
    v_lshl_add_u32 v7, v1, 8, v3
    v_add_u32 v15, 0x10000, v7
    v_lshlrev_b32 v3, 2, v1
    v_xor_b32 v3, v3, v2
    v_lshlrev_b32 v3, 4, v3
    v_lshl_add_u32 v9, v1, 8, v3
    v_add_u32 v10, 0x20000, v9
    s_mov_b32 s32, s96
    s_and_b32 s33, s97, 0xffff
    s_mov_b32 s34, 0x100
    s_mov_b32 s35, 0x00020000
    s_add_u32 s4, s98, 0x3000000
    s_addc_u32 s5, s99, 0
    s_mov_b32 s20, s4
    s_and_b32 s21, s5, 0xffff
    s_mov_b32 s22, 0x20000
    s_mov_b32 s23, 0x00020000
    s_and_b32 s40, s2, 7
    s_and_b32 s41, s14, 3
    s_lshl_b32 s42, s15, 3
    s_add_u32 s42, s42, s40
    s_lshl_b32 s36, s42, 8
    s_lshl_b32 s42, s15, 2
    s_add_u32 s42, s42, s41
    s_lshl_b32 s42, s42, 8
    s_add_u32 s37, s42, 0x10000
    s_lshl_b32 s41, s41, 2
    s_add_u32 s38, s36, s41
    s_lshl_b32 s40, s40, 2
    s_add_u32 s39, s37, s40
    s_getpc_b64 s[4:5]
L_pc:
    s_sub_u32 s4, s4, L_pc-standalone__gqa_block_cached__near_ridge_kernel
    s_subb_u32 s5, s5, 0
    s_lshr_b32 s6, s2, 3
    s_and_b32 s6, s6, 7
    s_cmp_ge_u32 s6, 6
    s_cselect_b32 s6, 0, s6
    s_lshl_b32 s6, s6, 13
    v_lshlrev_b32 v20, 7, v0
    v_add_u32 v20, s6, v20
    v_min_u32 v20, A_end-standalone__gqa_block_cached__near_ridge_kernel, v20
    global_load_dword v11, v20, s[4:5]
    s_cmp_eq_u32 s2, 0
    s_cbranch_scc0 L_noclr
    v_mov_b32 v16, 0
    v_mov_b32 v17, 0
    v_mov_b32 v18, 0
    v_mov_b32 v19, 0
    v_lshlrev_b32 v20, 8, v0
    v_add_u32 v21, 0x10000, v20
    buffer_store_dwordx4 v[16:19], v20, s[20:23], 0 offen sc1
    buffer_store_dwordx4 v[16:19], v21, s[20:23], 0 offen sc1
    buffer_store_dwordx4 v[16:19], v21, s[20:23], 0 offen offset:16 sc1
    s_nop 1
    v_mov_b32 v17, 1
    s_waitcnt vmcnt(0)
    v_cmp_eq_u32 vcc, 0, v0
    s_and_saveexec_b64 s[18:19], vcc
    buffer_store_dword v17, v16, s[32:35], 0 offen sc1
    s_mov_b64 exec, s[18:19]
    s_waitcnt vmcnt(0)
L_noclr:
    s_barrier
    s_mov_b32 s40, 0
    buffer_load_dwordx4 v[24:27], v8, s[24:27], s40 offen offset:0 nt
    buffer_load_dwordx4 v[28:31], v8, s[24:27], s40 offen offset:1024 nt
    buffer_load_dwordx4 v[32:35], v8, s[24:27], s40 offen offset:2048 nt
    buffer_load_dwordx4 v[36:39], v8, s[24:27], s40 offen offset:3072 nt
    s_mov_b32 s40, 4096
    buffer_load_dwordx4 v[40:43], v8, s[24:27], s40 offen offset:0 nt
    buffer_load_dwordx4 v[44:47], v8, s[24:27], s40 offen offset:1024 nt
    buffer_load_dwordx4 v[48:51], v8, s[24:27], s40 offen offset:2048 nt
    buffer_load_dwordx4 v[52:55], v8, s[24:27], s40 offen offset:3072 nt
    s_mov_b32 s40, 8192
    buffer_load_dwordx4 v[56:59], v8, s[24:27], s40 offen offset:0 nt
    buffer_load_dwordx4 v[60:63], v8, s[24:27], s40 offen offset:1024 nt
    buffer_load_dwordx4 v[64:67], v8, s[24:27], s40 offen offset:2048 nt
    buffer_load_dwordx4 v[68:71], v8, s[24:27], s40 offen offset:3072 nt
    s_mov_b32 s40, 12288
    buffer_load_dwordx4 v[72:75], v8, s[24:27], s40 offen offset:0 nt
    buffer_load_dwordx4 v[76:79], v8, s[24:27], s40 offen offset:1024 nt
    buffer_load_dwordx4 v[80:83], v8, s[24:27], s40 offen offset:2048 nt
    buffer_load_dwordx4 v[84:87], v8, s[24:27], s40 offen offset:3072 nt
    s_mov_b32 s40, 16384
    buffer_load_dwordx4 v[88:91], v8, s[24:27], s40 offen offset:0 nt
    buffer_load_dwordx4 v[92:95], v8, s[24:27], s40 offen offset:1024 nt
    buffer_load_dwordx4 v[96:99], v8, s[24:27], s40 offen offset:2048 nt
    buffer_load_dwordx4 v[100:103], v8, s[24:27], s40 offen offset:3072 nt
    s_mov_b32 s40, 20480
    buffer_load_dwordx4 v[104:107], v8, s[24:27], s40 offen offset:0 nt
    buffer_load_dwordx4 v[108:111], v8, s[24:27], s40 offen offset:1024 nt
    buffer_load_dwordx4 v[112:115], v8, s[24:27], s40 offen offset:2048 nt
    buffer_load_dwordx4 v[116:119], v8, s[24:27], s40 offen offset:3072 nt
    s_mov_b32 s40, 24576
    buffer_load_dwordx4 v[120:123], v8, s[24:27], s40 offen offset:0 nt
    buffer_load_dwordx4 v[124:127], v8, s[24:27], s40 offen offset:1024 nt
    buffer_load_dwordx4 v[128:131], v8, s[24:27], s40 offen offset:2048 nt
    buffer_load_dwordx4 v[132:135], v8, s[24:27], s40 offen offset:3072 nt
    s_mov_b32 s40, 28672
    buffer_load_dwordx4 v[136:139], v8, s[24:27], s40 offen offset:0 nt
    buffer_load_dwordx4 v[140:143], v8, s[24:27], s40 offen offset:1024 nt
    buffer_load_dwordx4 v[144:147], v8, s[24:27], s40 offen offset:2048 nt
    buffer_load_dwordx4 v[148:151], v8, s[24:27], s40 offen offset:3072 nt
    s_mov_b32 s40, 32768
    buffer_load_dwordx4 v[152:155], v8, s[24:27], s40 offen offset:0 nt
    buffer_load_dwordx4 v[156:159], v8, s[24:27], s40 offen offset:1024 nt
    buffer_load_dwordx4 v[160:163], v8, s[24:27], s40 offen offset:2048 nt
    buffer_load_dwordx4 v[164:167], v8, s[24:27], s40 offen offset:3072 nt
    s_mov_b32 s40, 36864
    buffer_load_dwordx4 v[168:171], v8, s[24:27], s40 offen offset:0 nt
    buffer_load_dwordx4 v[172:175], v8, s[24:27], s40 offen offset:1024 nt
    buffer_load_dwordx4 v[176:179], v8, s[24:27], s40 offen offset:2048 nt
    buffer_load_dwordx4 v[180:183], v8, s[24:27], s40 offen offset:3072 nt
    s_mov_b32 s40, 40960
    buffer_load_dwordx4 v[184:187], v8, s[24:27], s40 offen offset:0 nt
    buffer_load_dwordx4 v[188:191], v8, s[24:27], s40 offen offset:1024 nt
    buffer_load_dwordx4 v[192:195], v8, s[24:27], s40 offen offset:2048 nt
    buffer_load_dwordx4 v[196:199], v8, s[24:27], s40 offen offset:3072 nt
    s_mov_b32 s40, 45056
    buffer_load_dwordx4 v[200:203], v8, s[24:27], s40 offen offset:0 nt
    buffer_load_dwordx4 v[204:207], v8, s[24:27], s40 offen offset:1024 nt
    buffer_load_dwordx4 v[208:211], v8, s[24:27], s40 offen offset:2048 nt
    buffer_load_dwordx4 v[212:215], v8, s[24:27], s40 offen offset:3072 nt
    s_barrier
    s_mov_b32 s40, 49152
    buffer_load_dwordx4 v[216:219], v8, s[24:27], s40 offen offset:0 nt
    buffer_load_dwordx4 v[220:223], v8, s[24:27], s40 offen offset:1024 nt
    buffer_load_dwordx4 v[224:227], v8, s[24:27], s40 offen offset:2048 nt
    buffer_load_dwordx4 v[228:231], v8, s[24:27], s40 offen offset:3072 nt
    s_mov_b32 s40, 53248
    buffer_load_dwordx4 v[232:235], v8, s[24:27], s40 offen offset:0 nt
    buffer_load_dwordx4 v[236:239], v8, s[24:27], s40 offen offset:1024 nt
    buffer_load_dwordx4 v[240:243], v8, s[24:27], s40 offen offset:2048 nt
    buffer_load_dwordx4 v[244:247], v8, s[24:27], s40 offen offset:3072 nt
    s_mov_b32 s40, 57344
    buffer_load_dwordx4 v[248:251], v8, s[24:27], s40 offen offset:0 nt
    buffer_load_dwordx4 v[252:255], v8, s[24:27], s40 offen offset:1024 nt
    buffer_load_dwordx4 a[0:3], v8, s[24:27], s40 offen offset:2048 nt
    buffer_load_dwordx4 a[4:7], v8, s[24:27], s40 offen offset:3072 nt
    s_waitcnt vmcnt(60)
    s_mov_b32 s40, 61440
    buffer_load_dwordx4 a[8:11], v8, s[24:27], s40 offen offset:0 nt
    buffer_load_dwordx4 a[12:15], v8, s[24:27], s40 offen offset:1024 nt
    buffer_load_dwordx4 a[16:19], v8, s[24:27], s40 offen offset:2048 nt
    buffer_load_dwordx4 a[20:23], v8, s[24:27], s40 offen offset:3072 nt
    s_waitcnt vmcnt(60)
    s_mov_b32 s40, 65536
    buffer_load_dwordx4 a[24:27], v8, s[24:27], s40 offen offset:0 nt
    buffer_load_dwordx4 a[28:31], v8, s[24:27], s40 offen offset:1024 nt
    buffer_load_dwordx4 a[32:35], v8, s[24:27], s40 offen offset:2048 nt
    buffer_load_dwordx4 a[36:39], v8, s[24:27], s40 offen offset:3072 nt
    s_waitcnt vmcnt(60)
    s_mov_b32 s40, 69632
    buffer_load_dwordx4 a[40:43], v8, s[24:27], s40 offen offset:0 nt
    buffer_load_dwordx4 a[44:47], v8, s[24:27], s40 offen offset:1024 nt
    buffer_load_dwordx4 a[48:51], v8, s[24:27], s40 offen offset:2048 nt
    buffer_load_dwordx4 a[52:55], v8, s[24:27], s40 offen offset:3072 nt
    s_waitcnt vmcnt(60)
    s_mov_b32 s40, 73728
    buffer_load_dwordx4 a[56:59], v8, s[24:27], s40 offen offset:0 nt
    buffer_load_dwordx4 a[60:63], v8, s[24:27], s40 offen offset:1024 nt
    buffer_load_dwordx4 a[64:67], v8, s[24:27], s40 offen offset:2048 nt
    buffer_load_dwordx4 a[68:71], v8, s[24:27], s40 offen offset:3072 nt
    s_waitcnt vmcnt(60)
    s_mov_b32 s40, 77824
    buffer_load_dwordx4 a[72:75], v8, s[24:27], s40 offen offset:0 nt
    buffer_load_dwordx4 a[76:79], v8, s[24:27], s40 offen offset:1024 nt
    buffer_load_dwordx4 a[80:83], v8, s[24:27], s40 offen offset:2048 nt
    buffer_load_dwordx4 a[84:87], v8, s[24:27], s40 offen offset:3072 nt
    s_waitcnt vmcnt(60)
    s_mov_b32 s40, 81920
    buffer_load_dwordx4 a[88:91], v8, s[24:27], s40 offen offset:0 nt
    buffer_load_dwordx4 a[92:95], v8, s[24:27], s40 offen offset:1024 nt
    buffer_load_dwordx4 a[96:99], v8, s[24:27], s40 offen offset:2048 nt
    buffer_load_dwordx4 a[100:103], v8, s[24:27], s40 offen offset:3072 nt
    s_waitcnt vmcnt(60)
    s_mov_b32 s40, 86016
    buffer_load_dwordx4 a[104:107], v8, s[24:27], s40 offen offset:0 nt
    buffer_load_dwordx4 a[108:111], v8, s[24:27], s40 offen offset:1024 nt
    buffer_load_dwordx4 a[112:115], v8, s[24:27], s40 offen offset:2048 nt
    buffer_load_dwordx4 a[116:119], v8, s[24:27], s40 offen offset:3072 nt
    s_waitcnt vmcnt(60)
    s_mov_b32 s40, 90112
    buffer_load_dwordx4 a[120:123], v8, s[24:27], s40 offen offset:0 nt
    buffer_load_dwordx4 a[124:127], v8, s[24:27], s40 offen offset:1024 nt
    buffer_load_dwordx4 a[128:131], v8, s[24:27], s40 offen offset:2048 nt
    buffer_load_dwordx4 a[132:135], v8, s[24:27], s40 offen offset:3072 nt
    s_waitcnt vmcnt(60)
    s_mov_b32 s40, 94208
    buffer_load_dwordx4 a[136:139], v8, s[24:27], s40 offen offset:0 nt
    buffer_load_dwordx4 a[140:143], v8, s[24:27], s40 offen offset:1024 nt
    buffer_load_dwordx4 a[144:147], v8, s[24:27], s40 offen offset:2048 nt
    buffer_load_dwordx4 a[148:151], v8, s[24:27], s40 offen offset:3072 nt
    s_waitcnt vmcnt(60)
    s_mov_b32 s40, 98304
    buffer_load_dwordx4 a[152:155], v8, s[24:27], s40 offen offset:0 nt
    buffer_load_dwordx4 a[156:159], v8, s[24:27], s40 offen offset:1024 nt
    buffer_load_dwordx4 a[160:163], v8, s[24:27], s40 offen offset:2048 nt
    buffer_load_dwordx4 a[164:167], v8, s[24:27], s40 offen offset:3072 nt
    s_waitcnt vmcnt(60)
    s_mov_b32 s40, 102400
    buffer_load_dwordx4 a[168:171], v8, s[24:27], s40 offen offset:0 nt
    buffer_load_dwordx4 a[172:175], v8, s[24:27], s40 offen offset:1024 nt
    buffer_load_dwordx4 a[176:179], v8, s[24:27], s40 offen offset:2048 nt
    buffer_load_dwordx4 a[180:183], v8, s[24:27], s40 offen offset:3072 nt
    s_waitcnt vmcnt(60)
    s_mov_b32 s40, 106496
    buffer_load_dwordx4 a[184:187], v8, s[24:27], s40 offen offset:0 nt
    buffer_load_dwordx4 a[188:191], v8, s[24:27], s40 offen offset:1024 nt
    buffer_load_dwordx4 a[192:195], v8, s[24:27], s40 offen offset:2048 nt
    buffer_load_dwordx4 a[196:199], v8, s[24:27], s40 offen offset:3072 nt
    s_waitcnt vmcnt(60)
    s_mov_b32 s40, 110592
    buffer_load_dwordx4 a[200:203], v8, s[24:27], s40 offen offset:0 nt
    buffer_load_dwordx4 a[204:207], v8, s[24:27], s40 offen offset:1024 nt
    buffer_load_dwordx4 a[208:211], v8, s[24:27], s40 offen offset:2048 nt
    buffer_load_dwordx4 a[212:215], v8, s[24:27], s40 offen offset:3072 nt
    s_barrier
    ds_write_b128 v4, v[24:27] offset:0
    ds_write_b128 v5, v[28:31] offset:1024
    ds_write_b128 v6, v[32:35] offset:2048
    ds_write_b128 v7, v[36:39] offset:3072
    ds_write_b128 v4, v[40:43] offset:4096
    ds_write_b128 v5, v[44:47] offset:5120
    ds_write_b128 v6, v[48:51] offset:6144
    ds_write_b128 v7, v[52:55] offset:7168
    ds_write_b128 v4, v[56:59] offset:8192
    ds_write_b128 v5, v[60:63] offset:9216
    ds_write_b128 v6, v[64:67] offset:10240
    ds_write_b128 v7, v[68:71] offset:11264
    ds_write_b128 v4, v[72:75] offset:12288
    ds_write_b128 v5, v[76:79] offset:13312
    ds_write_b128 v6, v[80:83] offset:14336
    ds_write_b128 v7, v[84:87] offset:15360
    s_waitcnt lgkmcnt(0)
    s_barrier
    ds_write_b128 v4, v[88:91] offset:16384
    ds_write_b128 v5, v[92:95] offset:17408
    ds_write_b128 v6, v[96:99] offset:18432
    ds_write_b128 v7, v[100:103] offset:19456
    ds_write_b128 v4, v[104:107] offset:20480
    ds_write_b128 v5, v[108:111] offset:21504
    ds_write_b128 v6, v[112:115] offset:22528
    ds_write_b128 v7, v[116:119] offset:23552
    ds_write_b128 v4, v[120:123] offset:24576
    ds_write_b128 v5, v[124:127] offset:25600
    ds_write_b128 v6, v[128:131] offset:26624
    ds_write_b128 v7, v[132:135] offset:27648
    ds_write_b128 v4, v[136:139] offset:28672
    ds_write_b128 v5, v[140:143] offset:29696
    ds_write_b128 v6, v[144:147] offset:30720
    ds_write_b128 v7, v[148:151] offset:31744
    s_waitcnt lgkmcnt(0)
    ds_write_b128 v4, v[152:155] offset:32768
    ds_write_b128 v5, v[156:159] offset:33792
    ds_write_b128 v6, v[160:163] offset:34816
    ds_write_b128 v7, v[164:167] offset:35840
    ds_write_b128 v4, v[168:171] offset:36864
    ds_write_b128 v5, v[172:175] offset:37888
    ds_write_b128 v6, v[176:179] offset:38912
    ds_write_b128 v7, v[180:183] offset:39936
    ds_write_b128 v4, v[184:187] offset:40960
    ds_write_b128 v5, v[188:191] offset:41984
    ds_write_b128 v6, v[192:195] offset:43008
    ds_write_b128 v7, v[196:199] offset:44032
    ds_write_b128 v4, v[200:203] offset:45056
    ds_write_b128 v5, v[204:207] offset:46080
    ds_write_b128 v6, v[208:211] offset:47104
    ds_write_b128 v7, v[212:215] offset:48128
    s_waitcnt lgkmcnt(0)
    s_barrier
    s_waitcnt vmcnt(60)
    s_mov_b32 s40, 114688
    buffer_load_dwordx4 v[24:27], v8, s[24:27], s40 offen offset:0 nt
    buffer_load_dwordx4 v[28:31], v8, s[24:27], s40 offen offset:1024 nt
    buffer_load_dwordx4 v[32:35], v8, s[24:27], s40 offen offset:2048 nt
    buffer_load_dwordx4 v[36:39], v8, s[24:27], s40 offen offset:3072 nt
    s_waitcnt vmcnt(60)
    s_mov_b32 s40, 118784
    buffer_load_dwordx4 v[40:43], v8, s[24:27], s40 offen offset:0 nt
    buffer_load_dwordx4 v[44:47], v8, s[24:27], s40 offen offset:1024 nt
    buffer_load_dwordx4 v[48:51], v8, s[24:27], s40 offen offset:2048 nt
    buffer_load_dwordx4 v[52:55], v8, s[24:27], s40 offen offset:3072 nt
    s_waitcnt vmcnt(60)
    s_mov_b32 s40, 122880
    buffer_load_dwordx4 v[56:59], v8, s[24:27], s40 offen offset:0 nt
    buffer_load_dwordx4 v[60:63], v8, s[24:27], s40 offen offset:1024 nt
    buffer_load_dwordx4 v[64:67], v8, s[24:27], s40 offen offset:2048 nt
    buffer_load_dwordx4 v[68:71], v8, s[24:27], s40 offen offset:3072 nt
    s_waitcnt vmcnt(60)
    s_mov_b32 s40, 126976
    buffer_load_dwordx4 v[72:75], v8, s[24:27], s40 offen offset:0 nt
    buffer_load_dwordx4 v[76:79], v8, s[24:27], s40 offen offset:1024 nt
    buffer_load_dwordx4 v[80:83], v8, s[24:27], s40 offen offset:2048 nt
    buffer_load_dwordx4 v[84:87], v8, s[24:27], s40 offen offset:3072 nt
    ds_write_b128 v4, v[216:219] offset:49152
    ds_write_b128 v5, v[220:223] offset:50176
    ds_write_b128 v6, v[224:227] offset:51200
    ds_write_b128 v7, v[228:231] offset:52224
    ds_write_b128 v4, v[232:235] offset:53248
    ds_write_b128 v5, v[236:239] offset:54272
    ds_write_b128 v6, v[240:243] offset:55296
    ds_write_b128 v7, v[244:247] offset:56320
    ds_write_b128 v4, v[248:251] offset:57344
    ds_write_b128 v5, v[252:255] offset:58368
    ds_write_b128 v6, a[0:3] offset:59392
    ds_write_b128 v7, a[4:7] offset:60416
    ds_write_b128 v4, a[8:11] offset:61440
    ds_write_b128 v5, a[12:15] offset:62464
    ds_write_b128 v6, a[16:19] offset:63488
    ds_write_b128 v7, a[20:23] offset:64512
    s_waitcnt lgkmcnt(0)
    s_waitcnt vmcnt(60)
    s_mov_b32 s40, 0
    buffer_load_dwordx4 v[88:91], v8, s[28:31], s40 offen offset:0 nt
    buffer_load_dwordx4 v[92:95], v8, s[28:31], s40 offen offset:1024 nt
    buffer_load_dwordx4 v[96:99], v8, s[28:31], s40 offen offset:2048 nt
    buffer_load_dwordx4 v[100:103], v8, s[28:31], s40 offen offset:3072 nt
    s_waitcnt vmcnt(60)
    s_mov_b32 s40, 4096
    buffer_load_dwordx4 v[104:107], v8, s[28:31], s40 offen offset:0 nt
    buffer_load_dwordx4 v[108:111], v8, s[28:31], s40 offen offset:1024 nt
    buffer_load_dwordx4 v[112:115], v8, s[28:31], s40 offen offset:2048 nt
    buffer_load_dwordx4 v[116:119], v8, s[28:31], s40 offen offset:3072 nt
    s_waitcnt vmcnt(60)
    s_mov_b32 s40, 8192
    buffer_load_dwordx4 v[120:123], v8, s[28:31], s40 offen offset:0 nt
    buffer_load_dwordx4 v[124:127], v8, s[28:31], s40 offen offset:1024 nt
    buffer_load_dwordx4 v[128:131], v8, s[28:31], s40 offen offset:2048 nt
    buffer_load_dwordx4 v[132:135], v8, s[28:31], s40 offen offset:3072 nt
    s_waitcnt vmcnt(60)
    s_mov_b32 s40, 12288
    buffer_load_dwordx4 v[136:139], v8, s[28:31], s40 offen offset:0 nt
    buffer_load_dwordx4 v[140:143], v8, s[28:31], s40 offen offset:1024 nt
    buffer_load_dwordx4 v[144:147], v8, s[28:31], s40 offen offset:2048 nt
    buffer_load_dwordx4 v[148:151], v8, s[28:31], s40 offen offset:3072 nt
    ds_write_b128 v12, a[24:27] offset:0
    ds_write_b128 v13, a[28:31] offset:1024
    ds_write_b128 v14, a[32:35] offset:2048
    ds_write_b128 v15, a[36:39] offset:3072
    ds_write_b128 v12, a[40:43] offset:4096
    ds_write_b128 v13, a[44:47] offset:5120
    ds_write_b128 v14, a[48:51] offset:6144
    ds_write_b128 v15, a[52:55] offset:7168
    ds_write_b128 v12, a[56:59] offset:8192
    ds_write_b128 v13, a[60:63] offset:9216
    ds_write_b128 v14, a[64:67] offset:10240
    ds_write_b128 v15, a[68:71] offset:11264
    ds_write_b128 v12, a[72:75] offset:12288
    ds_write_b128 v13, a[76:79] offset:13312
    ds_write_b128 v14, a[80:83] offset:14336
    ds_write_b128 v15, a[84:87] offset:15360
    s_waitcnt lgkmcnt(0)
    s_barrier
    s_waitcnt vmcnt(60)
    s_mov_b32 s40, 16384
    buffer_load_dwordx4 v[152:155], v8, s[28:31], s40 offen offset:0 nt
    buffer_load_dwordx4 v[156:159], v8, s[28:31], s40 offen offset:1024 nt
    buffer_load_dwordx4 v[160:163], v8, s[28:31], s40 offen offset:2048 nt
    buffer_load_dwordx4 v[164:167], v8, s[28:31], s40 offen offset:3072 nt
    s_waitcnt vmcnt(60)
    s_mov_b32 s40, 20480
    buffer_load_dwordx4 v[168:171], v8, s[28:31], s40 offen offset:0 nt
    buffer_load_dwordx4 v[172:175], v8, s[28:31], s40 offen offset:1024 nt
    buffer_load_dwordx4 v[176:179], v8, s[28:31], s40 offen offset:2048 nt
    buffer_load_dwordx4 v[180:183], v8, s[28:31], s40 offen offset:3072 nt
    s_waitcnt vmcnt(60)
    s_mov_b32 s40, 24576
    buffer_load_dwordx4 v[184:187], v8, s[28:31], s40 offen offset:0 nt
    buffer_load_dwordx4 v[188:191], v8, s[28:31], s40 offen offset:1024 nt
    buffer_load_dwordx4 v[192:195], v8, s[28:31], s40 offen offset:2048 nt
    buffer_load_dwordx4 v[196:199], v8, s[28:31], s40 offen offset:3072 nt
    s_waitcnt vmcnt(60)
    s_mov_b32 s40, 28672
    buffer_load_dwordx4 v[200:203], v8, s[28:31], s40 offen offset:0 nt
    buffer_load_dwordx4 v[204:207], v8, s[28:31], s40 offen offset:1024 nt
    buffer_load_dwordx4 v[208:211], v8, s[28:31], s40 offen offset:2048 nt
    buffer_load_dwordx4 v[212:215], v8, s[28:31], s40 offen offset:3072 nt
    ds_write_b128 v12, a[88:91] offset:16384
    ds_write_b128 v13, a[92:95] offset:17408
    ds_write_b128 v14, a[96:99] offset:18432
    ds_write_b128 v15, a[100:103] offset:19456
    ds_write_b128 v12, a[104:107] offset:20480
    ds_write_b128 v13, a[108:111] offset:21504
    ds_write_b128 v14, a[112:115] offset:22528
    ds_write_b128 v15, a[116:119] offset:23552
    ds_write_b128 v12, a[120:123] offset:24576
    ds_write_b128 v13, a[124:127] offset:25600
    ds_write_b128 v14, a[128:131] offset:26624
    ds_write_b128 v15, a[132:135] offset:27648
    ds_write_b128 v12, a[136:139] offset:28672
    ds_write_b128 v13, a[140:143] offset:29696
    ds_write_b128 v14, a[144:147] offset:30720
    ds_write_b128 v15, a[148:151] offset:31744
    s_waitcnt lgkmcnt(0)
    s_waitcnt vmcnt(60)
    s_mov_b32 s40, 32768
    buffer_load_dwordx4 v[216:219], v8, s[28:31], s40 offen offset:0 nt
    buffer_load_dwordx4 v[220:223], v8, s[28:31], s40 offen offset:1024 nt
    buffer_load_dwordx4 v[224:227], v8, s[28:31], s40 offen offset:2048 nt
    buffer_load_dwordx4 v[228:231], v8, s[28:31], s40 offen offset:3072 nt
    s_waitcnt vmcnt(60)
    s_mov_b32 s40, 36864
    buffer_load_dwordx4 v[232:235], v8, s[28:31], s40 offen offset:0 nt
    buffer_load_dwordx4 v[236:239], v8, s[28:31], s40 offen offset:1024 nt
    buffer_load_dwordx4 v[240:243], v8, s[28:31], s40 offen offset:2048 nt
    buffer_load_dwordx4 v[244:247], v8, s[28:31], s40 offen offset:3072 nt
    s_waitcnt vmcnt(60)
    s_mov_b32 s40, 40960
    buffer_load_dwordx4 v[248:251], v8, s[28:31], s40 offen offset:0 nt
    buffer_load_dwordx4 v[252:255], v8, s[28:31], s40 offen offset:1024 nt
    buffer_load_dwordx4 a[0:3], v8, s[28:31], s40 offen offset:2048 nt
    buffer_load_dwordx4 a[4:7], v8, s[28:31], s40 offen offset:3072 nt
    s_waitcnt vmcnt(60)
    s_mov_b32 s40, 45056
    buffer_load_dwordx4 a[8:11], v8, s[28:31], s40 offen offset:0 nt
    buffer_load_dwordx4 a[12:15], v8, s[28:31], s40 offen offset:1024 nt
    buffer_load_dwordx4 a[16:19], v8, s[28:31], s40 offen offset:2048 nt
    buffer_load_dwordx4 a[20:23], v8, s[28:31], s40 offen offset:3072 nt
    ds_write_b128 v12, a[152:155] offset:32768
    ds_write_b128 v13, a[156:159] offset:33792
    ds_write_b128 v14, a[160:163] offset:34816
    ds_write_b128 v15, a[164:167] offset:35840
    ds_write_b128 v12, a[168:171] offset:36864
    ds_write_b128 v13, a[172:175] offset:37888
    ds_write_b128 v14, a[176:179] offset:38912
    ds_write_b128 v15, a[180:183] offset:39936
    ds_write_b128 v12, a[184:187] offset:40960
    ds_write_b128 v13, a[188:191] offset:41984
    ds_write_b128 v14, a[192:195] offset:43008
    ds_write_b128 v15, a[196:199] offset:44032
    ds_write_b128 v12, a[200:203] offset:45056
    ds_write_b128 v13, a[204:207] offset:46080
    ds_write_b128 v14, a[208:211] offset:47104
    ds_write_b128 v15, a[212:215] offset:48128
    s_waitcnt lgkmcnt(0)
    s_barrier
    s_waitcnt vmcnt(60)
    s_mov_b32 s40, 49152
    buffer_load_dwordx4 a[24:27], v8, s[28:31], s40 offen offset:0 nt
    buffer_load_dwordx4 a[28:31], v8, s[28:31], s40 offen offset:1024 nt
    buffer_load_dwordx4 a[32:35], v8, s[28:31], s40 offen offset:2048 nt
    buffer_load_dwordx4 a[36:39], v8, s[28:31], s40 offen offset:3072 nt
    s_waitcnt vmcnt(60)
    s_mov_b32 s40, 53248
    buffer_load_dwordx4 a[40:43], v8, s[28:31], s40 offen offset:0 nt
    buffer_load_dwordx4 a[44:47], v8, s[28:31], s40 offen offset:1024 nt
    buffer_load_dwordx4 a[48:51], v8, s[28:31], s40 offen offset:2048 nt
    buffer_load_dwordx4 a[52:55], v8, s[28:31], s40 offen offset:3072 nt
    s_waitcnt vmcnt(60)
    s_mov_b32 s40, 57344
    buffer_load_dwordx4 a[56:59], v8, s[28:31], s40 offen offset:0 nt
    buffer_load_dwordx4 a[60:63], v8, s[28:31], s40 offen offset:1024 nt
    buffer_load_dwordx4 a[64:67], v8, s[28:31], s40 offen offset:2048 nt
    buffer_load_dwordx4 a[68:71], v8, s[28:31], s40 offen offset:3072 nt
    s_waitcnt vmcnt(60)
    s_mov_b32 s40, 61440
    buffer_load_dwordx4 a[72:75], v8, s[28:31], s40 offen offset:0 nt
    buffer_load_dwordx4 a[76:79], v8, s[28:31], s40 offen offset:1024 nt
    buffer_load_dwordx4 a[80:83], v8, s[28:31], s40 offen offset:2048 nt
    buffer_load_dwordx4 a[84:87], v8, s[28:31], s40 offen offset:3072 nt
    ds_write_b128 v12, v[24:27] offset:49152
    ds_write_b128 v13, v[28:31] offset:50176
    ds_write_b128 v14, v[32:35] offset:51200
    ds_write_b128 v15, v[36:39] offset:52224
    ds_write_b128 v12, v[40:43] offset:53248
    ds_write_b128 v13, v[44:47] offset:54272
    ds_write_b128 v14, v[48:51] offset:55296
    ds_write_b128 v15, v[52:55] offset:56320
    ds_write_b128 v12, v[56:59] offset:57344
    ds_write_b128 v13, v[60:63] offset:58368
    ds_write_b128 v14, v[64:67] offset:59392
    ds_write_b128 v15, v[68:71] offset:60416
    ds_write_b128 v12, v[72:75] offset:61440
    ds_write_b128 v13, v[76:79] offset:62464
    ds_write_b128 v14, v[80:83] offset:63488
    ds_write_b128 v15, v[84:87] offset:64512
    s_waitcnt lgkmcnt(0)
    s_barrier
    s_waitcnt vmcnt(60)
    s_mov_b32 s40, 65536
    buffer_load_dwordx4 a[88:91], v8, s[28:31], s40 offen offset:0 nt
    buffer_load_dwordx4 a[92:95], v8, s[28:31], s40 offen offset:1024 nt
    buffer_load_dwordx4 a[96:99], v8, s[28:31], s40 offen offset:2048 nt
    buffer_load_dwordx4 a[100:103], v8, s[28:31], s40 offen offset:3072 nt
    s_waitcnt vmcnt(60)
    s_mov_b32 s40, 69632
    buffer_load_dwordx4 a[104:107], v8, s[28:31], s40 offen offset:0 nt
    buffer_load_dwordx4 a[108:111], v8, s[28:31], s40 offen offset:1024 nt
    buffer_load_dwordx4 a[112:115], v8, s[28:31], s40 offen offset:2048 nt
    buffer_load_dwordx4 a[116:119], v8, s[28:31], s40 offen offset:3072 nt
    s_waitcnt vmcnt(60)
    s_mov_b32 s40, 73728
    buffer_load_dwordx4 a[120:123], v8, s[28:31], s40 offen offset:0 nt
    buffer_load_dwordx4 a[124:127], v8, s[28:31], s40 offen offset:1024 nt
    buffer_load_dwordx4 a[128:131], v8, s[28:31], s40 offen offset:2048 nt
    buffer_load_dwordx4 a[132:135], v8, s[28:31], s40 offen offset:3072 nt
    s_waitcnt vmcnt(60)
    s_mov_b32 s40, 77824
    buffer_load_dwordx4 a[136:139], v8, s[28:31], s40 offen offset:0 nt
    buffer_load_dwordx4 a[140:143], v8, s[28:31], s40 offen offset:1024 nt
    buffer_load_dwordx4 a[144:147], v8, s[28:31], s40 offen offset:2048 nt
    buffer_load_dwordx4 a[148:151], v8, s[28:31], s40 offen offset:3072 nt
    ds_write_b128 v10, v[88:91] offset:0
    ds_write_b128 v10, v[92:95] offset:1024
    ds_write_b128 v10, v[96:99] offset:2048
    ds_write_b128 v10, v[100:103] offset:3072
    ds_write_b128 v10, v[104:107] offset:4096
    ds_write_b128 v10, v[108:111] offset:5120
    ds_write_b128 v10, v[112:115] offset:6144
    ds_write_b128 v10, v[116:119] offset:7168
    ds_write_b128 v10, v[120:123] offset:8192
    ds_write_b128 v10, v[124:127] offset:9216
    ds_write_b128 v10, v[128:131] offset:10240
    ds_write_b128 v10, v[132:135] offset:11264
    ds_write_b128 v10, v[136:139] offset:12288
    ds_write_b128 v10, v[140:143] offset:13312
    ds_write_b128 v10, v[144:147] offset:14336
    ds_write_b128 v10, v[148:151] offset:15360
    s_waitcnt lgkmcnt(0)
    s_waitcnt vmcnt(60)
    s_mov_b32 s40, 81920
    buffer_load_dwordx4 a[152:155], v8, s[28:31], s40 offen offset:0 nt
    buffer_load_dwordx4 a[156:159], v8, s[28:31], s40 offen offset:1024 nt
    buffer_load_dwordx4 a[160:163], v8, s[28:31], s40 offen offset:2048 nt
    buffer_load_dwordx4 a[164:167], v8, s[28:31], s40 offen offset:3072 nt
    s_waitcnt vmcnt(60)
    s_mov_b32 s40, 86016
    buffer_load_dwordx4 a[168:171], v8, s[28:31], s40 offen offset:0 nt
    buffer_load_dwordx4 a[172:175], v8, s[28:31], s40 offen offset:1024 nt
    buffer_load_dwordx4 a[176:179], v8, s[28:31], s40 offen offset:2048 nt
    buffer_load_dwordx4 a[180:183], v8, s[28:31], s40 offen offset:3072 nt
    s_waitcnt vmcnt(60)
    s_mov_b32 s40, 90112
    buffer_load_dwordx4 a[184:187], v8, s[28:31], s40 offen offset:0 nt
    buffer_load_dwordx4 a[188:191], v8, s[28:31], s40 offen offset:1024 nt
    buffer_load_dwordx4 a[192:195], v8, s[28:31], s40 offen offset:2048 nt
    buffer_load_dwordx4 a[196:199], v8, s[28:31], s40 offen offset:3072 nt
    s_waitcnt vmcnt(60)
    s_mov_b32 s40, 94208
    buffer_load_dwordx4 a[200:203], v8, s[28:31], s40 offen offset:0 nt
    buffer_load_dwordx4 a[204:207], v8, s[28:31], s40 offen offset:1024 nt
    buffer_load_dwordx4 a[208:211], v8, s[28:31], s40 offen offset:2048 nt
    buffer_load_dwordx4 a[212:215], v8, s[28:31], s40 offen offset:3072 nt
    ds_write_b128 v10, v[152:155] offset:16384
    ds_write_b128 v10, v[156:159] offset:17408
    ds_write_b128 v10, v[160:163] offset:18432
    ds_write_b128 v10, v[164:167] offset:19456
    ds_write_b128 v10, v[168:171] offset:20480
    ds_write_b128 v10, v[172:175] offset:21504
    ds_write_b128 v10, v[176:179] offset:22528
    ds_write_b128 v10, v[180:183] offset:23552
    ds_write_b128 v10, v[184:187] offset:24576
    ds_write_b128 v10, v[188:191] offset:25600
    ds_write_b128 v10, v[192:195] offset:26624
    ds_write_b128 v10, v[196:199] offset:27648
    ds_write_b128 v10, v[200:203] offset:28672
    ds_write_b128 v10, v[204:207] offset:29696
    ds_write_b128 v10, v[208:211] offset:30720
    ds_write_b128 v10, v[212:215] offset:31744
    s_waitcnt lgkmcnt(0)
    s_barrier
    s_waitcnt vmcnt(60)
    s_mov_b32 m0, 65536
    s_mov_b32 s40, 98304
    buffer_load_dwordx4 v9, s[28:31], s40 offen offset:0 nt lds
    buffer_load_dwordx4 v9, s[28:31], s40 offen offset:1024 nt lds
    buffer_load_dwordx4 v9, s[28:31], s40 offen offset:2048 nt lds
    buffer_load_dwordx4 v9, s[28:31], s40 offen offset:3072 nt lds
    s_waitcnt vmcnt(60)
    s_mov_b32 m0, 69632
    s_mov_b32 s40, 102400
    buffer_load_dwordx4 v9, s[28:31], s40 offen offset:0 nt lds
    buffer_load_dwordx4 v9, s[28:31], s40 offen offset:1024 nt lds
    buffer_load_dwordx4 v9, s[28:31], s40 offen offset:2048 nt lds
    buffer_load_dwordx4 v9, s[28:31], s40 offen offset:3072 nt lds
    s_waitcnt vmcnt(60)
    s_mov_b32 m0, 73728
    s_mov_b32 s40, 106496
    buffer_load_dwordx4 v9, s[28:31], s40 offen offset:0 nt lds
    buffer_load_dwordx4 v9, s[28:31], s40 offen offset:1024 nt lds
    buffer_load_dwordx4 v9, s[28:31], s40 offen offset:2048 nt lds
    buffer_load_dwordx4 v9, s[28:31], s40 offen offset:3072 nt lds
    s_waitcnt vmcnt(60)
    s_mov_b32 m0, 77824
    s_mov_b32 s40, 110592
    buffer_load_dwordx4 v9, s[28:31], s40 offen offset:0 nt lds
    buffer_load_dwordx4 v9, s[28:31], s40 offen offset:1024 nt lds
    buffer_load_dwordx4 v9, s[28:31], s40 offen offset:2048 nt lds
    buffer_load_dwordx4 v9, s[28:31], s40 offen offset:3072 nt lds
    ds_write_b128 v9, v[216:219] offset:0
    ds_write_b128 v9, v[220:223] offset:1024
    ds_write_b128 v9, v[224:227] offset:2048
    ds_write_b128 v9, v[228:231] offset:3072
    ds_write_b128 v9, v[232:235] offset:4096
    ds_write_b128 v9, v[236:239] offset:5120
    ds_write_b128 v9, v[240:243] offset:6144
    ds_write_b128 v9, v[244:247] offset:7168
    ds_write_b128 v9, v[248:251] offset:8192
    ds_write_b128 v9, v[252:255] offset:9216
    ds_write_b128 v9, a[0:3] offset:10240
    ds_write_b128 v9, a[4:7] offset:11264
    ds_write_b128 v9, a[8:11] offset:12288
    ds_write_b128 v9, a[12:15] offset:13312
    ds_write_b128 v9, a[16:19] offset:14336
    ds_write_b128 v9, a[20:23] offset:15360
    s_waitcnt lgkmcnt(0)
    s_waitcnt vmcnt(60)
    s_mov_b32 m0, 81920
    s_mov_b32 s40, 114688
    buffer_load_dwordx4 v9, s[28:31], s40 offen offset:0 nt lds
    buffer_load_dwordx4 v9, s[28:31], s40 offen offset:1024 nt lds
    buffer_load_dwordx4 v9, s[28:31], s40 offen offset:2048 nt lds
    buffer_load_dwordx4 v9, s[28:31], s40 offen offset:3072 nt lds
    s_waitcnt vmcnt(60)
    s_mov_b32 m0, 86016
    s_mov_b32 s40, 118784
    buffer_load_dwordx4 v9, s[28:31], s40 offen offset:0 nt lds
    buffer_load_dwordx4 v9, s[28:31], s40 offen offset:1024 nt lds
    buffer_load_dwordx4 v9, s[28:31], s40 offen offset:2048 nt lds
    buffer_load_dwordx4 v9, s[28:31], s40 offen offset:3072 nt lds
    s_waitcnt vmcnt(60)
    s_mov_b32 m0, 90112
    s_mov_b32 s40, 122880
    buffer_load_dwordx4 v9, s[28:31], s40 offen offset:0 nt lds
    buffer_load_dwordx4 v9, s[28:31], s40 offen offset:1024 nt lds
    buffer_load_dwordx4 v9, s[28:31], s40 offen offset:2048 nt lds
    buffer_load_dwordx4 v9, s[28:31], s40 offen offset:3072 nt lds
    s_waitcnt vmcnt(60)
    s_mov_b32 m0, 94208
    s_mov_b32 s40, 126976
    buffer_load_dwordx4 v9, s[28:31], s40 offen offset:0 nt lds
    buffer_load_dwordx4 v9, s[28:31], s40 offen offset:1024 nt lds
    buffer_load_dwordx4 v9, s[28:31], s40 offen offset:2048 nt lds
    buffer_load_dwordx4 v9, s[28:31], s40 offen offset:3072 nt lds
    v_add_u32 v21, 0, v0
    v_mul_u32_u24 v22, 205, v21
    v_lshrrev_b32 v22, 12, v22
    v_mul_u32_u24 v23, 20, v22
    v_sub_u32 v21, v21, v23
    v_mul_u32_u24 v22, 1280, v22
    v_lshl_add_u32 v16, v21, 4, v22
    v_add_u32 v21, 64, v0
    v_mul_u32_u24 v22, 205, v21
    v_lshrrev_b32 v22, 12, v22
    v_mul_u32_u24 v23, 20, v22
    v_sub_u32 v21, v21, v23
    v_mul_u32_u24 v22, 1280, v22
    v_lshl_add_u32 v17, v21, 4, v22
    v_add_u32 v21, 128, v0
    v_mul_u32_u24 v22, 205, v21
    v_lshrrev_b32 v22, 12, v22
    v_mul_u32_u24 v23, 20, v22
    v_sub_u32 v21, v21, v23
    v_mul_u32_u24 v22, 1280, v22
    v_lshl_add_u32 v18, v21, 4, v22
    v_add_u32 v21, 192, v0
    v_mul_u32_u24 v22, 205, v21
    v_lshrrev_b32 v22, 12, v22
    v_mul_u32_u24 v23, 20, v22
    v_sub_u32 v21, v21, v23
    v_mul_u32_u24 v22, 1280, v22
    v_lshl_add_u32 v19, v21, 4, v22
    v_add_u32 v21, 256, v0
    v_mul_u32_u24 v22, 205, v21
    v_lshrrev_b32 v22, 12, v22
    v_mul_u32_u24 v23, 20, v22
    v_sub_u32 v21, v21, v23
    v_mul_u32_u24 v22, 1280, v22
    v_lshl_add_u32 v20, v21, 4, v22
    s_and_b32 s45, s14, 3
    s_lshl_b32 s45, s45, 3
    v_mov_b32 v21, 0
    s_lshl_b32 s40, s15, 5
    s_add_u32 s40, s40, s14
    s_mul_i32 s40, s40, 24576
    s_and_b32 s42, s14, 3
    s_lshl_b32 s43, s15, 2
    s_add_u32 s42, s42, s43
    s_mul_i32 s42, s42, 245760
    s_and_b32 s43, s2, 7
    s_mul_i32 s43, s43, 30720
    s_add_u32 s42, s42, s43
    s_add_u32 s42, s42, 0x2000000
    s_mul_i32 s43, s15, 122880
    s_mov_b32 s8, s98
    s_and_b32 s9, s99, 0xffff
    s_mov_b32 s10, 0x4000000
    s_mov_b32 s11, 0x00020000
    s_mov_b32 s4, s100
    s_and_b32 s5, s101, 0xffff
    s_mov_b32 s6, 0xf0000
    s_mov_b32 s7, 0x00020000
    s_mov_b64 exec, 1
    buffer_load_dword v11, v21, s[8:11], s40 offen
    buffer_load_dword v11, v21, s[8:11], s42 offen sc1
    buffer_load_dword v11, v21, s[20:23], s36 offen sc1
    buffer_load_dword v11, v21, s[4:7], s43 offen
    s_mov_b64 exec, -1
    s_lshl_b32 s40, s15, 2
    s_and_b32 s41, s14, 3
    s_add_u32 s40, s40, s41
    s_mul_i32 s40, s40, 20480
    s_mul_i32 s41, s41, 320
    s_sub_u32 s40, s40, s41
    v_lshlrev_b32 v21, 7, v0
    v_add_u32 v22, 8192, v21
    v_and_b32 v23, 31, v0
    v_lshlrev_b32 v23, 7, v23
    v_add_u32 v23, 16384, v23
    buffer_load_dword v11, v21, s[48:51], s40 offen
    buffer_load_dword v11, v22, s[48:51], s40 offen
    buffer_load_dword v11, v23, s[48:51], s40 offen
    s_load_dword s47, s[96:97], 0
    ds_write_b128 v9, a[24:27] offset:16384
    ds_write_b128 v9, a[28:31] offset:17408
    ds_write_b128 v9, a[32:35] offset:18432
    ds_write_b128 v9, a[36:39] offset:19456
    ds_write_b128 v9, a[40:43] offset:20480
    ds_write_b128 v9, a[44:47] offset:21504
    ds_write_b128 v9, a[48:51] offset:22528
    ds_write_b128 v9, a[52:55] offset:23552
    ds_write_b128 v9, a[56:59] offset:24576
    ds_write_b128 v9, a[60:63] offset:25600
    ds_write_b128 v9, a[64:67] offset:26624
    ds_write_b128 v9, a[68:71] offset:27648
    ds_write_b128 v9, a[72:75] offset:28672
    ds_write_b128 v9, a[76:79] offset:29696
    ds_write_b128 v9, a[80:83] offset:30720
    ds_write_b128 v9, a[84:87] offset:31744
    s_waitcnt lgkmcnt(0)
    s_barrier
    s_waitcnt vmcnt(55)
    ds_write_b128 v9, a[88:91] offset:32768
    ds_write_b128 v9, a[92:95] offset:33792
    ds_write_b128 v9, a[96:99] offset:34816
    ds_write_b128 v9, a[100:103] offset:35840
    ds_write_b128 v9, a[104:107] offset:36864
    ds_write_b128 v9, a[108:111] offset:37888
    ds_write_b128 v9, a[112:115] offset:38912
    ds_write_b128 v9, a[116:119] offset:39936
    ds_write_b128 v9, a[120:123] offset:40960
    ds_write_b128 v9, a[124:127] offset:41984
    ds_write_b128 v9, a[128:131] offset:43008
    ds_write_b128 v9, a[132:135] offset:44032
    ds_write_b128 v9, a[136:139] offset:45056
    ds_write_b128 v9, a[140:143] offset:46080
    ds_write_b128 v9, a[144:147] offset:47104
    ds_write_b128 v9, a[148:151] offset:48128
    s_waitcnt lgkmcnt(0)
    s_barrier
    s_add_u32 s40, s45, 0
    s_and_b32 s40, s40, 31
    s_mul_i32 s40, s40, 20480
    s_mov_b32 m0, 102400
    s_nop 0
    buffer_load_dwordx4 v16, s[48:51], s40 offen lds
    s_mov_b32 m0, 103424
    s_nop 0
    buffer_load_dwordx4 v17, s[48:51], s40 offen lds
    s_mov_b32 m0, 104448
    s_nop 0
    buffer_load_dwordx4 v18, s[48:51], s40 offen lds
    s_mov_b32 m0, 105472
    s_nop 0
    buffer_load_dwordx4 v19, s[48:51], s40 offen lds
    s_mov_b32 m0, 106496
    s_nop 0
    buffer_load_dwordx4 v20, s[48:51], s40 offen lds
    s_waitcnt vmcnt(55)
    s_add_u32 s40, s45, 1
    s_and_b32 s40, s40, 31
    s_mul_i32 s40, s40, 20480
    s_mov_b32 m0, 107520
    s_nop 0
    buffer_load_dwordx4 v16, s[48:51], s40 offen lds
    s_mov_b32 m0, 108544
    s_nop 0
    buffer_load_dwordx4 v17, s[48:51], s40 offen lds
    s_mov_b32 m0, 109568
    s_nop 0
    buffer_load_dwordx4 v18, s[48:51], s40 offen lds
    s_mov_b32 m0, 110592
    s_nop 0
    buffer_load_dwordx4 v19, s[48:51], s40 offen lds
    s_mov_b32 m0, 111616
    s_nop 0
    buffer_load_dwordx4 v20, s[48:51], s40 offen lds
    s_waitcnt vmcnt(49)
    ds_write_b128 v9, a[152:155] offset:49152
    ds_write_b128 v9, a[156:159] offset:50176
    ds_write_b128 v9, a[160:163] offset:51200
    ds_write_b128 v9, a[164:167] offset:52224
    ds_write_b128 v9, a[168:171] offset:53248
    ds_write_b128 v9, a[172:175] offset:54272
    ds_write_b128 v9, a[176:179] offset:55296
    ds_write_b128 v9, a[180:183] offset:56320
    ds_write_b128 v9, a[184:187] offset:57344
    ds_write_b128 v9, a[188:191] offset:58368
    ds_write_b128 v9, a[192:195] offset:59392
    ds_write_b128 v9, a[196:199] offset:60416
    ds_write_b128 v9, a[200:203] offset:61440
    ds_write_b128 v9, a[204:207] offset:62464
    ds_write_b128 v9, a[208:211] offset:63488
    ds_write_b128 v9, a[212:215] offset:64512
    s_waitcnt lgkmcnt(0)
    s_barrier
    s_add_u32 s40, s45, 2
    s_and_b32 s40, s40, 31
    s_mul_i32 s40, s40, 20480
    s_mov_b32 m0, 112640
    s_nop 0
    buffer_load_dwordx4 v16, s[48:51], s40 offen lds
    s_mov_b32 m0, 113664
    s_nop 0
    buffer_load_dwordx4 v17, s[48:51], s40 offen lds
    s_mov_b32 m0, 114688
    s_nop 0
    buffer_load_dwordx4 v18, s[48:51], s40 offen lds
    s_mov_b32 m0, 115712
    s_nop 0
    buffer_load_dwordx4 v19, s[48:51], s40 offen lds
    s_mov_b32 m0, 116736
    s_nop 0
    buffer_load_dwordx4 v20, s[48:51], s40 offen lds
    s_add_u32 s40, s45, 3
    s_and_b32 s40, s40, 31
    s_mul_i32 s40, s40, 20480
    s_mov_b32 m0, 117760
    s_nop 0
    buffer_load_dwordx4 v16, s[48:51], s40 offen lds
    s_mov_b32 m0, 118784
    s_nop 0
    buffer_load_dwordx4 v17, s[48:51], s40 offen lds
    s_mov_b32 m0, 119808
    s_nop 0
    buffer_load_dwordx4 v18, s[48:51], s40 offen lds
    s_mov_b32 m0, 120832
    s_nop 0
    buffer_load_dwordx4 v19, s[48:51], s40 offen lds
    s_mov_b32 m0, 121856
    s_nop 0
    buffer_load_dwordx4 v20, s[48:51], s40 offen lds
    s_waitcnt vmcnt(55)
    s_add_u32 s40, s45, 4
    s_and_b32 s40, s40, 31
    s_mul_i32 s40, s40, 20480
    s_mov_b32 m0, 122880
    s_nop 0
    buffer_load_dwordx4 v16, s[48:51], s40 offen lds
    s_mov_b32 m0, 123904
    s_nop 0
    buffer_load_dwordx4 v17, s[48:51], s40 offen lds
    s_mov_b32 m0, 124928
    s_nop 0
    buffer_load_dwordx4 v18, s[48:51], s40 offen lds
    s_mov_b32 m0, 125952
    s_nop 0
    buffer_load_dwordx4 v19, s[48:51], s40 offen lds
    s_mov_b32 m0, 126976
    s_nop 0
    buffer_load_dwordx4 v20, s[48:51], s40 offen lds
    s_waitcnt vmcnt(48)
    s_barrier
    s_add_u32 s40, s45, 5
    s_and_b32 s40, s40, 31
    s_mul_i32 s40, s40, 20480
    s_mov_b32 m0, 128000
    s_nop 0
    buffer_load_dwordx4 v16, s[48:51], s40 offen lds
    s_mov_b32 m0, 129024
    s_nop 0
    buffer_load_dwordx4 v17, s[48:51], s40 offen lds
    s_mov_b32 m0, 130048
    s_nop 0
    buffer_load_dwordx4 v18, s[48:51], s40 offen lds
    s_mov_b32 m0, 131072
    s_nop 0
    buffer_load_dwordx4 v19, s[48:51], s40 offen lds
    s_mov_b32 m0, 132096
    s_nop 0
    buffer_load_dwordx4 v20, s[48:51], s40 offen lds
    s_add_u32 s40, s45, 6
    s_and_b32 s40, s40, 31
    s_mul_i32 s40, s40, 20480
    s_mov_b32 m0, 133120
    s_nop 0
    buffer_load_dwordx4 v16, s[48:51], s40 offen lds
    s_mov_b32 m0, 134144
    s_nop 0
    buffer_load_dwordx4 v17, s[48:51], s40 offen lds
    s_mov_b32 m0, 135168
    s_nop 0
    buffer_load_dwordx4 v18, s[48:51], s40 offen lds
    s_mov_b32 m0, 136192
    s_nop 0
    buffer_load_dwordx4 v19, s[48:51], s40 offen lds
    s_mov_b32 m0, 137216
    s_nop 0
    buffer_load_dwordx4 v20, s[48:51], s40 offen lds
    s_waitcnt vmcnt(55)
    s_add_u32 s40, s45, 7
    s_and_b32 s40, s40, 31
    s_mul_i32 s40, s40, 20480
    s_mov_b32 m0, 138240
    s_nop 0
    buffer_load_dwordx4 v16, s[48:51], s40 offen lds
    s_mov_b32 m0, 139264
    s_nop 0
    buffer_load_dwordx4 v17, s[48:51], s40 offen lds
    s_mov_b32 m0, 140288
    s_nop 0
    buffer_load_dwordx4 v18, s[48:51], s40 offen lds
    s_mov_b32 m0, 141312
    s_nop 0
    buffer_load_dwordx4 v19, s[48:51], s40 offen lds
    s_mov_b32 m0, 142336
    s_nop 0
    buffer_load_dwordx4 v20, s[48:51], s40 offen lds
    s_waitcnt vmcnt(47)
    s_barrier
    s_add_u32 s40, s45, 8
    s_and_b32 s40, s40, 31
    s_mul_i32 s40, s40, 20480
    s_mov_b32 m0, 143360
    s_nop 0
    buffer_load_dwordx4 v16, s[48:51], s40 offen lds
    s_mov_b32 m0, 144384
    s_nop 0
    buffer_load_dwordx4 v17, s[48:51], s40 offen lds
    s_mov_b32 m0, 145408
    s_nop 0
    buffer_load_dwordx4 v18, s[48:51], s40 offen lds
    s_mov_b32 m0, 146432
    s_nop 0
    buffer_load_dwordx4 v19, s[48:51], s40 offen lds
    s_mov_b32 m0, 147456
    s_nop 0
    buffer_load_dwordx4 v20, s[48:51], s40 offen lds
    s_add_u32 s40, s45, 9
    s_and_b32 s40, s40, 31
    s_mul_i32 s40, s40, 20480
    s_mov_b32 m0, 148480
    s_nop 0
    buffer_load_dwordx4 v16, s[48:51], s40 offen lds
    s_mov_b32 m0, 149504
    s_nop 0
    buffer_load_dwordx4 v17, s[48:51], s40 offen lds
    s_mov_b32 m0, 150528
    s_nop 0
    buffer_load_dwordx4 v18, s[48:51], s40 offen lds
    s_mov_b32 m0, 151552
    s_nop 0
    buffer_load_dwordx4 v19, s[48:51], s40 offen lds
    s_mov_b32 m0, 152576
    s_nop 0
    buffer_load_dwordx4 v20, s[48:51], s40 offen lds
    s_waitcnt vmcnt(55)
    s_add_u32 s40, s45, 10
    s_and_b32 s40, s40, 31
    s_mul_i32 s40, s40, 20480
    s_mov_b32 m0, 153600
    s_nop 0
    buffer_load_dwordx4 v16, s[48:51], s40 offen lds
    s_mov_b32 m0, 154624
    s_nop 0
    buffer_load_dwordx4 v17, s[48:51], s40 offen lds
    s_mov_b32 m0, 155648
    s_nop 0
    buffer_load_dwordx4 v18, s[48:51], s40 offen lds
    s_mov_b32 m0, 156672
    s_nop 0
    buffer_load_dwordx4 v19, s[48:51], s40 offen lds
    s_mov_b32 m0, 157696
    s_nop 0
    buffer_load_dwordx4 v20, s[48:51], s40 offen lds
    s_waitcnt vmcnt(55)
    s_add_u32 s40, s45, 11
    s_and_b32 s40, s40, 31
    s_mul_i32 s40, s40, 20480
    s_mov_b32 m0, 158720
    s_nop 0
    buffer_load_dwordx4 v16, s[48:51], s40 offen lds
    s_mov_b32 m0, 159744
    s_nop 0
    buffer_load_dwordx4 v17, s[48:51], s40 offen lds
    s_mov_b32 m0, 160768
    s_nop 0
    buffer_load_dwordx4 v18, s[48:51], s40 offen lds
    s_mov_b32 m0, 161792
    s_nop 0
    buffer_load_dwordx4 v19, s[48:51], s40 offen lds
    s_mov_b32 m0, 162816
    s_nop 0
    buffer_load_dwordx4 v20, s[48:51], s40 offen lds
    s_waitcnt vmcnt(55)
    s_add_u32 s40, s45, 12
    s_and_b32 s40, s40, 31
    s_mul_i32 s40, s40, 20480
    s_mov_b32 m0, 0
    s_nop 0
    buffer_load_dwordx4 v16, s[48:51], s40 offen lds
    s_mov_b32 m0, 1024
    s_nop 0
    buffer_load_dwordx4 v17, s[48:51], s40 offen lds
    s_mov_b32 m0, 2048
    s_nop 0
    buffer_load_dwordx4 v18, s[48:51], s40 offen lds
    s_mov_b32 m0, 3072
    s_nop 0
    buffer_load_dwordx4 v19, s[48:51], s40 offen lds
    s_mov_b32 m0, 4096
    s_nop 0
    buffer_load_dwordx4 v20, s[48:51], s40 offen lds
    s_waitcnt vmcnt(55)
    s_add_u32 s40, s45, 13
    s_and_b32 s40, s40, 31
    s_mul_i32 s40, s40, 20480
    s_mov_b32 m0, 5120
    s_nop 0
    buffer_load_dwordx4 v16, s[48:51], s40 offen lds
    s_mov_b32 m0, 6144
    s_nop 0
    buffer_load_dwordx4 v17, s[48:51], s40 offen lds
    s_mov_b32 m0, 7168
    s_nop 0
    buffer_load_dwordx4 v18, s[48:51], s40 offen lds
    s_mov_b32 m0, 8192
    s_nop 0
    buffer_load_dwordx4 v19, s[48:51], s40 offen lds
    s_mov_b32 m0, 9216
    s_nop 0
    buffer_load_dwordx4 v20, s[48:51], s40 offen lds
    s_waitcnt vmcnt(55)
    s_add_u32 s40, s45, 14
    s_and_b32 s40, s40, 31
    s_mul_i32 s40, s40, 20480
    s_mov_b32 m0, 10240
    s_nop 0
    buffer_load_dwordx4 v16, s[48:51], s40 offen lds
    s_mov_b32 m0, 11264
    s_nop 0
    buffer_load_dwordx4 v17, s[48:51], s40 offen lds
    s_mov_b32 m0, 12288
    s_nop 0
    buffer_load_dwordx4 v18, s[48:51], s40 offen lds
    s_mov_b32 m0, 13312
    s_nop 0
    buffer_load_dwordx4 v19, s[48:51], s40 offen lds
    s_mov_b32 m0, 14336
    s_nop 0
    buffer_load_dwordx4 v20, s[48:51], s40 offen lds
    s_waitcnt vmcnt(55)
    s_add_u32 s40, s45, 15
    s_and_b32 s40, s40, 31
    s_mul_i32 s40, s40, 20480
    s_mov_b32 m0, 15360
    s_nop 0
    buffer_load_dwordx4 v16, s[48:51], s40 offen lds
    s_mov_b32 m0, 16384
    s_nop 0
    buffer_load_dwordx4 v17, s[48:51], s40 offen lds
    s_mov_b32 m0, 17408
    s_nop 0
    buffer_load_dwordx4 v18, s[48:51], s40 offen lds
    s_mov_b32 m0, 18432
    s_nop 0
    buffer_load_dwordx4 v19, s[48:51], s40 offen lds
    s_mov_b32 m0, 19456
    s_nop 0
    buffer_load_dwordx4 v20, s[48:51], s40 offen lds
    s_and_b32 s42, s14, 3
    s_lshl_b32 s43, s15, 2
    s_add_u32 s42, s42, s43
    s_mul_i32 s42, s42, 245760
    s_add_u32 s42, s42, 0x2000000
    s_add_u32 s6, s98, s42
    s_addc_u32 s7, s99, 0
    s_mov_b32 s28, s6
    s_and_b32 s29, s7, 0xffff
    s_mov_b32 s30, 0x3c000
    s_mov_b32 s31, 0x00020000
    s_waitcnt vmcnt(40)
    s_barrier
    s_add_u32 s40, s45, 16
    s_and_b32 s40, s40, 31
    s_mul_i32 s40, s40, 20480
    s_mov_b32 m0, 20480
    s_nop 0
    buffer_load_dwordx4 v16, s[48:51], s40 offen lds
    s_mov_b32 m0, 21504
    s_nop 0
    buffer_load_dwordx4 v17, s[48:51], s40 offen lds
    s_mov_b32 m0, 22528
    s_nop 0
    buffer_load_dwordx4 v18, s[48:51], s40 offen lds
    s_mov_b32 m0, 23552
    s_nop 0
    buffer_load_dwordx4 v19, s[48:51], s40 offen lds
    s_mov_b32 m0, 24576
    s_nop 0
    buffer_load_dwordx4 v20, s[48:51], s40 offen lds
    s_add_u32 s40, s45, 17
    s_and_b32 s40, s40, 31
    s_mul_i32 s40, s40, 20480
    s_mov_b32 m0, 25600
    s_nop 0
    buffer_load_dwordx4 v16, s[48:51], s40 offen lds
    s_mov_b32 m0, 26624
    s_nop 0
    buffer_load_dwordx4 v17, s[48:51], s40 offen lds
    s_mov_b32 m0, 27648
    s_nop 0
    buffer_load_dwordx4 v18, s[48:51], s40 offen lds
    s_mov_b32 m0, 28672
    s_nop 0
    buffer_load_dwordx4 v19, s[48:51], s40 offen lds
    s_mov_b32 m0, 29696
    s_nop 0
    buffer_load_dwordx4 v20, s[48:51], s40 offen lds
    s_add_u32 s40, s45, 18
    s_and_b32 s40, s40, 31
    s_mul_i32 s40, s40, 20480
    s_mov_b32 m0, 30720
    s_nop 0
    buffer_load_dwordx4 v16, s[48:51], s40 offen lds
    s_mov_b32 m0, 31744
    s_nop 0
    buffer_load_dwordx4 v17, s[48:51], s40 offen lds
    s_mov_b32 m0, 32768
    s_nop 0
    buffer_load_dwordx4 v18, s[48:51], s40 offen lds
    s_mov_b32 m0, 33792
    s_nop 0
    buffer_load_dwordx4 v19, s[48:51], s40 offen lds
    s_mov_b32 m0, 34816
    s_nop 0
    buffer_load_dwordx4 v20, s[48:51], s40 offen lds
    s_add_u32 s40, s45, 19
    s_and_b32 s40, s40, 31
    s_mul_i32 s40, s40, 20480
    s_mov_b32 m0, 35840
    s_nop 0
    buffer_load_dwordx4 v16, s[48:51], s40 offen lds
    s_mov_b32 m0, 36864
    s_nop 0
    buffer_load_dwordx4 v17, s[48:51], s40 offen lds
    s_mov_b32 m0, 37888
    s_nop 0
    buffer_load_dwordx4 v18, s[48:51], s40 offen lds
    s_mov_b32 m0, 38912
    s_nop 0
    buffer_load_dwordx4 v19, s[48:51], s40 offen lds
    s_mov_b32 m0, 39936
    s_nop 0
    buffer_load_dwordx4 v20, s[48:51], s40 offen lds
    s_waitcnt vmcnt(55)
    s_add_u32 s40, s45, 20
    s_and_b32 s40, s40, 31
    s_mul_i32 s40, s40, 20480
    s_mov_b32 m0, 40960
    s_nop 0
    buffer_load_dwordx4 v16, s[48:51], s40 offen lds
    s_mov_b32 m0, 41984
    s_nop 0
    buffer_load_dwordx4 v17, s[48:51], s40 offen lds
    s_mov_b32 m0, 43008
    s_nop 0
    buffer_load_dwordx4 v18, s[48:51], s40 offen lds
    s_mov_b32 m0, 44032
    s_nop 0
    buffer_load_dwordx4 v19, s[48:51], s40 offen lds
    s_mov_b32 m0, 45056
    s_nop 0
    buffer_load_dwordx4 v20, s[48:51], s40 offen lds
    s_waitcnt vmcnt(55)
    s_add_u32 s40, s45, 21
    s_and_b32 s40, s40, 31
    s_mul_i32 s40, s40, 20480
    s_mov_b32 m0, 46080
    s_nop 0
    buffer_load_dwordx4 v16, s[48:51], s40 offen lds
    s_mov_b32 m0, 47104
    s_nop 0
    buffer_load_dwordx4 v17, s[48:51], s40 offen lds
    s_mov_b32 m0, 48128
    s_nop 0
    buffer_load_dwordx4 v18, s[48:51], s40 offen lds
    s_mov_b32 m0, 49152
    s_nop 0
    buffer_load_dwordx4 v19, s[48:51], s40 offen lds
    s_mov_b32 m0, 50176
    s_nop 0
    buffer_load_dwordx4 v20, s[48:51], s40 offen lds
    s_waitcnt vmcnt(55)
    s_add_u32 s40, s45, 22
    s_and_b32 s40, s40, 31
    s_mul_i32 s40, s40, 20480
    s_mov_b32 m0, 51200
    s_nop 0
    buffer_load_dwordx4 v16, s[48:51], s40 offen lds
    s_mov_b32 m0, 52224
    s_nop 0
    buffer_load_dwordx4 v17, s[48:51], s40 offen lds
    s_mov_b32 m0, 53248
    s_nop 0
    buffer_load_dwordx4 v18, s[48:51], s40 offen lds
    s_mov_b32 m0, 54272
    s_nop 0
    buffer_load_dwordx4 v19, s[48:51], s40 offen lds
    s_mov_b32 m0, 55296
    s_nop 0
    buffer_load_dwordx4 v20, s[48:51], s40 offen lds
    s_waitcnt vmcnt(55)
    s_add_u32 s40, s45, 23
    s_and_b32 s40, s40, 31
    s_mul_i32 s40, s40, 20480
    s_mov_b32 m0, 56320
    s_nop 0
    buffer_load_dwordx4 v16, s[48:51], s40 offen lds
    s_mov_b32 m0, 57344
    s_nop 0
    buffer_load_dwordx4 v17, s[48:51], s40 offen lds
    s_mov_b32 m0, 58368
    s_nop 0
    buffer_load_dwordx4 v18, s[48:51], s40 offen lds
    s_mov_b32 m0, 59392
    s_nop 0
    buffer_load_dwordx4 v19, s[48:51], s40 offen lds
    s_mov_b32 m0, 60416
    s_nop 0
    buffer_load_dwordx4 v20, s[48:51], s40 offen lds
    s_cmp_ge_u32 s47, 1
    s_cbranch_scc1 C_done
    v_mov_b32 v2, 0
    s_mov_b32 s56, 0
C_poll:
    buffer_load_dword v1, v2, s[32:35], 0 offen sc1
    s_waitcnt vmcnt(0)
    v_readfirstlane_b32 s57, v1
    s_add_u32 s56, s56, 1
    s_cmp_ge_u32 s56, 0x40000
    s_cbranch_scc1 C_done
    s_cmp_ge_u32 s57, 1
    s_cbranch_scc1 C_done
    s_sleep 16
    s_branch C_poll
C_done:
    v_mov_b32 v1, 1
    v_mov_b32 v3, 0
    v_and_b32 v2, 3, v0
    v_lshlrev_b32 v2, 2, v2
    v_cmp_eq_u32 vcc, 0, v0
    s_barrier
    s_and_saveexec_b64 s[18:19], vcc
    buffer_store_dword v1, v3, s[20:23], s38 offen sc1
    s_mov_b64 exec, s[18:19]
    s_waitcnt vmcnt(55)
    s_add_u32 s40, s45, 24
    s_and_b32 s40, s40, 31
    s_mul_i32 s40, s40, 20480
    s_mov_b32 m0, 61440
    s_nop 0
    buffer_load_dwordx4 v16, s[48:51], s40 offen lds
    s_mov_b32 m0, 62464
    s_nop 0
    buffer_load_dwordx4 v17, s[48:51], s40 offen lds
    s_mov_b32 m0, 63488
    s_nop 0
    buffer_load_dwordx4 v18, s[48:51], s40 offen lds
    s_mov_b32 m0, 64512
    s_nop 0
    buffer_load_dwordx4 v19, s[48:51], s40 offen lds
    s_mov_b32 m0, 65536
    s_nop 0
    buffer_load_dwordx4 v20, s[48:51], s40 offen lds
    s_waitcnt vmcnt(55)
    s_add_u32 s40, s45, 25
    s_and_b32 s40, s40, 31
    s_mul_i32 s40, s40, 20480
    s_mov_b32 m0, 66560
    s_nop 0
    buffer_load_dwordx4 v16, s[48:51], s40 offen lds
    s_mov_b32 m0, 67584
    s_nop 0
    buffer_load_dwordx4 v17, s[48:51], s40 offen lds
    s_mov_b32 m0, 68608
    s_nop 0
    buffer_load_dwordx4 v18, s[48:51], s40 offen lds
    s_mov_b32 m0, 69632
    s_nop 0
    buffer_load_dwordx4 v19, s[48:51], s40 offen lds
    s_mov_b32 m0, 70656
    s_nop 0
    buffer_load_dwordx4 v20, s[48:51], s40 offen lds
    s_waitcnt vmcnt(55)
    s_add_u32 s40, s45, 26
    s_and_b32 s40, s40, 31
    s_mul_i32 s40, s40, 20480
    s_mov_b32 m0, 71680
    s_nop 0
    buffer_load_dwordx4 v16, s[48:51], s40 offen lds
    s_mov_b32 m0, 72704
    s_nop 0
    buffer_load_dwordx4 v17, s[48:51], s40 offen lds
    s_mov_b32 m0, 73728
    s_nop 0
    buffer_load_dwordx4 v18, s[48:51], s40 offen lds
    s_mov_b32 m0, 74752
    s_nop 0
    buffer_load_dwordx4 v19, s[48:51], s40 offen lds
    s_mov_b32 m0, 75776
    s_nop 0
    buffer_load_dwordx4 v20, s[48:51], s40 offen lds
    s_waitcnt vmcnt(55)
    s_add_u32 s40, s45, 27
    s_and_b32 s40, s40, 31
    s_mul_i32 s40, s40, 20480
    s_mov_b32 m0, 76800
    s_nop 0
    buffer_load_dwordx4 v16, s[48:51], s40 offen lds
    s_mov_b32 m0, 77824
    s_nop 0
    buffer_load_dwordx4 v17, s[48:51], s40 offen lds
    s_mov_b32 m0, 78848
    s_nop 0
    buffer_load_dwordx4 v18, s[48:51], s40 offen lds
    s_mov_b32 m0, 79872
    s_nop 0
    buffer_load_dwordx4 v19, s[48:51], s40 offen lds
    s_mov_b32 m0, 80896
    s_nop 0
    buffer_load_dwordx4 v20, s[48:51], s40 offen lds
    s_waitcnt vmcnt(55)
    s_add_u32 s40, s45, 28
    s_and_b32 s40, s40, 31
    s_mul_i32 s40, s40, 20480
    s_mov_b32 m0, 81920
    s_nop 0
    buffer_load_dwordx4 v16, s[48:51], s40 offen lds
    s_mov_b32 m0, 82944
    s_nop 0
    buffer_load_dwordx4 v17, s[48:51], s40 offen lds
    s_mov_b32 m0, 83968
    s_nop 0
    buffer_load_dwordx4 v18, s[48:51], s40 offen lds
    s_mov_b32 m0, 84992
    s_nop 0
    buffer_load_dwordx4 v19, s[48:51], s40 offen lds
    s_mov_b32 m0, 86016
    s_nop 0
    buffer_load_dwordx4 v20, s[48:51], s40 offen lds
    s_waitcnt vmcnt(55)
    s_add_u32 s40, s45, 29
    s_and_b32 s40, s40, 31
    s_mul_i32 s40, s40, 20480
    s_mov_b32 m0, 87040
    s_nop 0
    buffer_load_dwordx4 v16, s[48:51], s40 offen lds
    s_mov_b32 m0, 88064
    s_nop 0
    buffer_load_dwordx4 v17, s[48:51], s40 offen lds
    s_mov_b32 m0, 89088
    s_nop 0
    buffer_load_dwordx4 v18, s[48:51], s40 offen lds
    s_mov_b32 m0, 90112
    s_nop 0
    buffer_load_dwordx4 v19, s[48:51], s40 offen lds
    s_mov_b32 m0, 91136
    s_nop 0
    buffer_load_dwordx4 v20, s[48:51], s40 offen lds
    s_waitcnt vmcnt(55)
    s_add_u32 s40, s45, 30
    s_and_b32 s40, s40, 31
    s_mul_i32 s40, s40, 20480
    s_mov_b32 m0, 92160
    s_nop 0
    buffer_load_dwordx4 v16, s[48:51], s40 offen lds
    s_mov_b32 m0, 93184
    s_nop 0
    buffer_load_dwordx4 v17, s[48:51], s40 offen lds
    s_mov_b32 m0, 94208
    s_nop 0
    buffer_load_dwordx4 v18, s[48:51], s40 offen lds
    s_mov_b32 m0, 95232
    s_nop 0
    buffer_load_dwordx4 v19, s[48:51], s40 offen lds
    s_mov_b32 m0, 96256
    s_nop 0
    buffer_load_dwordx4 v20, s[48:51], s40 offen lds
    s_waitcnt vmcnt(55)
    s_add_u32 s40, s45, 31
    s_and_b32 s40, s40, 31
    s_mul_i32 s40, s40, 20480
    s_mov_b32 m0, 97280
    s_nop 0
    buffer_load_dwordx4 v16, s[48:51], s40 offen lds
    s_mov_b32 m0, 98304
    s_nop 0
    buffer_load_dwordx4 v17, s[48:51], s40 offen lds
    s_mov_b32 m0, 99328
    s_nop 0
    buffer_load_dwordx4 v18, s[48:51], s40 offen lds
    s_mov_b32 m0, 100352
    s_nop 0
    buffer_load_dwordx4 v19, s[48:51], s40 offen lds
    s_mov_b32 m0, 101376
    s_nop 0
    buffer_load_dwordx4 v20, s[48:51], s40 offen lds
    s_waitcnt vmcnt(55)
    s_mov_b32 s46, 0
    buffer_load_dword v100, v2, s[20:23], s36 offen sc1
    s_sleep 4
    buffer_load_dword v101, v2, s[20:23], s36 offen sc1
    s_sleep 4
    buffer_load_dword v102, v2, s[20:23], s36 offen sc1
    s_sleep 4
    buffer_load_dword v103, v2, s[20:23], s36 offen sc1
S1_poll:
    s_waitcnt vmcnt(3)
    v_cmp_ne_u32 vcc, 1, v100
    s_nop 1
    s_cmp_eq_u64 vcc, 0
    s_cbranch_scc1 S1_done
    buffer_load_dword v100, v2, s[20:23], s36 offen sc1
    s_waitcnt vmcnt(3)
    v_cmp_ne_u32 vcc, 1, v101
    s_nop 1
    s_cmp_eq_u64 vcc, 0
    s_cbranch_scc1 S1_done
    buffer_load_dword v101, v2, s[20:23], s36 offen sc1
    s_waitcnt vmcnt(3)
    v_cmp_ne_u32 vcc, 1, v102
    s_nop 1
    s_cmp_eq_u64 vcc, 0
    s_cbranch_scc1 S1_done
    buffer_load_dword v102, v2, s[20:23], s36 offen sc1
    s_waitcnt vmcnt(3)
    v_cmp_ne_u32 vcc, 1, v103
    s_nop 1
    s_cmp_eq_u64 vcc, 0
    s_cbranch_scc1 S1_done
    buffer_load_dword v103, v2, s[20:23], s36 offen sc1
    s_add_u32 s46, s46, 1
    s_cmp_lt_u32 s46, 0x10000
    s_cbranch_scc1 S1_poll
S1_done:
    s_barrier
    v_mov_b32 v1, 1
    v_mov_b32 v3, 0
    v_and_b32 v2, 7, v0
    v_lshlrev_b32 v2, 2, v2
    v_cmp_eq_u32 vcc, 0, v0
    s_barrier
    s_and_saveexec_b64 s[18:19], vcc
    buffer_store_dword v1, v3, s[20:23], s39 offen sc1
    s_mov_b64 exec, s[18:19]
    s_mov_b32 s46, 0
    buffer_load_dword v110, v2, s[20:23], s37 offen sc1
    s_sleep 4
    buffer_load_dword v111, v2, s[20:23], s37 offen sc1
    s_sleep 4
    buffer_load_dword v112, v2, s[20:23], s37 offen sc1
    s_sleep 4
    buffer_load_dword v113, v2, s[20:23], s37 offen sc1
S2_poll:
    s_waitcnt vmcnt(3)
    v_cmp_ne_u32 vcc, 1, v110
    s_nop 1
    s_cmp_eq_u64 vcc, 0
    s_cbranch_scc1 S2_done
    buffer_load_dword v110, v2, s[20:23], s37 offen sc1
    s_waitcnt vmcnt(3)
    v_cmp_ne_u32 vcc, 1, v111
    s_nop 1
    s_cmp_eq_u64 vcc, 0
    s_cbranch_scc1 S2_done
    buffer_load_dword v111, v2, s[20:23], s37 offen sc1
    s_waitcnt vmcnt(3)
    v_cmp_ne_u32 vcc, 1, v112
    s_nop 1
    s_cmp_eq_u64 vcc, 0
    s_cbranch_scc1 S2_done
    buffer_load_dword v112, v2, s[20:23], s37 offen sc1
    s_waitcnt vmcnt(3)
    v_cmp_ne_u32 vcc, 1, v113
    s_nop 1
    s_cmp_eq_u64 vcc, 0
    s_cbranch_scc1 S2_done
    buffer_load_dword v113, v2, s[20:23], s37 offen sc1
    s_add_u32 s46, s46, 1
    s_cmp_lt_u32 s46, 0x10000
    s_cbranch_scc1 S2_poll
S2_done:
    s_barrier
R_start:
    s_and_b32 s40, s2, 7
    s_lshl_b32 s40, s40, 2
    s_add_u32 s40, s40, s16
    s_cmp_ge_u32 s40, 30
    s_cbranch_scc1 A_end
    v_lshlrev_b32 v1, 4, v0
    s_lshl_b32 s41, s40, 10
    buffer_load_dwordx4 v[32:35], v1, s[28:31], s41 offen sc1
    s_add_u32 s41, s41, 30720
    buffer_load_dwordx4 v[36:39], v1, s[28:31], s41 offen sc1
    s_add_u32 s41, s41, 30720
    buffer_load_dwordx4 v[40:43], v1, s[28:31], s41 offen sc1
    s_add_u32 s41, s41, 30720
    buffer_load_dwordx4 v[44:47], v1, s[28:31], s41 offen sc1
    s_add_u32 s41, s41, 30720
    buffer_load_dwordx4 v[48:51], v1, s[28:31], s41 offen sc1
    s_add_u32 s41, s41, 30720
    buffer_load_dwordx4 v[52:55], v1, s[28:31], s41 offen sc1
    s_add_u32 s41, s41, 30720
    buffer_load_dwordx4 v[56:59], v1, s[28:31], s41 offen sc1
    s_add_u32 s41, s41, 30720
    buffer_load_dwordx4 v[60:63], v1, s[28:31], s41 offen sc1
    s_mul_i32 s42, s15, 122880
    s_and_b32 s43, s14, 3
    s_mul_i32 s43, s43, 320
    s_add_u32 s42, s42, s43
    s_add_u32 s4, s100, s42
    s_addc_u32 s5, s101, 0
    s_sub_u32 s42, 983040, s42
    s_mov_b32 s20, s4
    s_and_b32 s21, s5, 0xffff
    s_mov_b32 s22, s42
    s_mov_b32 s23, 0x00020000
    s_mul_i32 s42, s40, 26
    s_lshr_b32 s42, s42, 8
    s_mul_i32 s43, s42, 10
    s_sub_u32 s43, s40, s43
    s_mul_i32 s42, s42, 40960
    s_lshl_b32 s43, s43, 5
    s_add_u32 s42, s42, s43
    v_and_b32 v2, 31, v0
    v_lshrrev_b32 v3, 5, v0
    v_mul_u32_u24 v2, 1280, v2
    v_lshl_add_u32 v2, v3, 4, v2
    s_waitcnt vmcnt(7)
    v_lshlrev_b32 v24, 16, v32
    v_and_b32 v25, 0xffff0000, v32
    v_lshlrev_b32 v26, 16, v33
    v_and_b32 v27, 0xffff0000, v33
    v_lshlrev_b32 v28, 16, v34
    v_and_b32 v29, 0xffff0000, v34
    v_lshlrev_b32 v30, 16, v35
    v_and_b32 v31, 0xffff0000, v35
    s_waitcnt vmcnt(6)
    v_lshlrev_b32 v72, 16, v36
    v_and_b32 v73, 0xffff0000, v36
    v_lshlrev_b32 v74, 16, v37
    v_and_b32 v75, 0xffff0000, v37
    v_lshlrev_b32 v76, 16, v38
    v_and_b32 v77, 0xffff0000, v38
    v_lshlrev_b32 v78, 16, v39
    v_and_b32 v79, 0xffff0000, v39
    v_pk_add_f32 v[24:25], v[24:25], v[72:73]
    v_pk_add_f32 v[26:27], v[26:27], v[74:75]
    v_pk_add_f32 v[28:29], v[28:29], v[76:77]
    v_pk_add_f32 v[30:31], v[30:31], v[78:79]
    s_waitcnt vmcnt(5)
    v_lshlrev_b32 v64, 16, v40
    v_and_b32 v65, 0xffff0000, v40
    v_lshlrev_b32 v66, 16, v41
    v_and_b32 v67, 0xffff0000, v41
    v_lshlrev_b32 v68, 16, v42
    v_and_b32 v69, 0xffff0000, v42
    v_lshlrev_b32 v70, 16, v43
    v_and_b32 v71, 0xffff0000, v43
    v_pk_add_f32 v[24:25], v[24:25], v[64:65]
    v_pk_add_f32 v[26:27], v[26:27], v[66:67]
    v_pk_add_f32 v[28:29], v[28:29], v[68:69]
    v_pk_add_f32 v[30:31], v[30:31], v[70:71]
    s_waitcnt vmcnt(4)
    v_lshlrev_b32 v72, 16, v44
    v_and_b32 v73, 0xffff0000, v44
    v_lshlrev_b32 v74, 16, v45
    v_and_b32 v75, 0xffff0000, v45
    v_lshlrev_b32 v76, 16, v46
    v_and_b32 v77, 0xffff0000, v46
    v_lshlrev_b32 v78, 16, v47
    v_and_b32 v79, 0xffff0000, v47
    v_pk_add_f32 v[24:25], v[24:25], v[72:73]
    v_pk_add_f32 v[26:27], v[26:27], v[74:75]
    v_pk_add_f32 v[28:29], v[28:29], v[76:77]
    v_pk_add_f32 v[30:31], v[30:31], v[78:79]
    s_waitcnt vmcnt(3)
    v_lshlrev_b32 v64, 16, v48
    v_and_b32 v65, 0xffff0000, v48
    v_lshlrev_b32 v66, 16, v49
    v_and_b32 v67, 0xffff0000, v49
    v_lshlrev_b32 v68, 16, v50
    v_and_b32 v69, 0xffff0000, v50
    v_lshlrev_b32 v70, 16, v51
    v_and_b32 v71, 0xffff0000, v51
    v_pk_add_f32 v[24:25], v[24:25], v[64:65]
    v_pk_add_f32 v[26:27], v[26:27], v[66:67]
    v_pk_add_f32 v[28:29], v[28:29], v[68:69]
    v_pk_add_f32 v[30:31], v[30:31], v[70:71]
    s_waitcnt vmcnt(2)
    v_lshlrev_b32 v72, 16, v52
    v_and_b32 v73, 0xffff0000, v52
    v_lshlrev_b32 v74, 16, v53
    v_and_b32 v75, 0xffff0000, v53
    v_lshlrev_b32 v76, 16, v54
    v_and_b32 v77, 0xffff0000, v54
    v_lshlrev_b32 v78, 16, v55
    v_and_b32 v79, 0xffff0000, v55
    v_pk_add_f32 v[24:25], v[24:25], v[72:73]
    v_pk_add_f32 v[26:27], v[26:27], v[74:75]
    v_pk_add_f32 v[28:29], v[28:29], v[76:77]
    v_pk_add_f32 v[30:31], v[30:31], v[78:79]
    s_waitcnt vmcnt(1)
    v_lshlrev_b32 v64, 16, v56
    v_and_b32 v65, 0xffff0000, v56
    v_lshlrev_b32 v66, 16, v57
    v_and_b32 v67, 0xffff0000, v57
    v_lshlrev_b32 v68, 16, v58
    v_and_b32 v69, 0xffff0000, v58
    v_lshlrev_b32 v70, 16, v59
    v_and_b32 v71, 0xffff0000, v59
    v_pk_add_f32 v[24:25], v[24:25], v[64:65]
    v_pk_add_f32 v[26:27], v[26:27], v[66:67]
    v_pk_add_f32 v[28:29], v[28:29], v[68:69]
    v_pk_add_f32 v[30:31], v[30:31], v[70:71]
    s_waitcnt vmcnt(0)
    v_lshlrev_b32 v72, 16, v60
    v_and_b32 v73, 0xffff0000, v60
    v_lshlrev_b32 v74, 16, v61
    v_and_b32 v75, 0xffff0000, v61
    v_lshlrev_b32 v76, 16, v62
    v_and_b32 v77, 0xffff0000, v62
    v_lshlrev_b32 v78, 16, v63
    v_and_b32 v79, 0xffff0000, v63
    v_pk_add_f32 v[24:25], v[24:25], v[72:73]
    v_pk_add_f32 v[26:27], v[26:27], v[74:75]
    v_pk_add_f32 v[28:29], v[28:29], v[76:77]
    v_pk_add_f32 v[30:31], v[30:31], v[78:79]
    v_cvt_pk_bf16_f32 v4, v24, v25
    v_cvt_pk_bf16_f32 v5, v26, v27
    v_cvt_pk_bf16_f32 v6, v28, v29
    v_cvt_pk_bf16_f32 v7, v30, v31
    buffer_store_dwordx4 v[4:7], v2, s[20:23], s42 offen
A_end:
    s_endpgm

.section .rodata,"a"
.p2align 6
.amdhsa_kernel standalone__gqa_block_cached__near_ridge_kernel
  .amdhsa_next_free_vgpr 512
  .amdhsa_next_free_sgpr 102
  .amdhsa_accum_offset 256
  .amdhsa_group_segment_fixed_size 0
  .amdhsa_kernarg_size 64
  .amdhsa_user_sgpr_count 2
  .amdhsa_user_sgpr_kernarg_segment_ptr 1
  .amdhsa_system_sgpr_workgroup_id_x 1
.end_amdhsa_kernel
```
